```python
import torch

def _softmax(x, axis=-1):
    return torch.softmax(x, dim=axis)
def _gelu(x):
    return torch.nn.functional.gelu(x, approximate="tanh")
def _silu(x):
    return torch.nn.functional.silu(x)
def _sigmoid(x):
    return torch.sigmoid(x)
def _layernorm(x, axis=-1, eps=1e-5):
    m = x.mean(dim=axis, keepdim=True)
    v = x.var(dim=axis, keepdim=True, unbiased=False)
    return (x - m) / torch.sqrt(v + eps)
def _scatter_add(tgt, idx, src, axis=0):
    return tgt.clone().index_add_(axis, idx, src)
def _segment_sum(src, seg, n):
    out = torch.zeros((n,) + src.shape[1:], dtype=src.dtype)
    return out.index_add_(0, seg, src)
def _pad(x, pw):
    flat = tuple(v for pair in reversed(pw) for v in pair)
    return torch.nn.functional.pad(x, flat)

kernel_name = 'recurrent_scan__ssm_conv_h3__dense_activation_squared_relu__prompt'

def setup_inputs():

    _w = (lambda a: (lambda t: t.to(torch.bfloat16) if t.is_floating_point() else t)(torch.as_tensor(a)))
    def _A_setup():
        B, S, D = 1, 2048, 448
        ks = 4
        return {
            "q": _w((lambda *s: torch.randn(*s, dtype=torch.bfloat16) * 0.05)(B, S, D)),
            "k": _w((lambda *s: torch.randn(*s, dtype=torch.bfloat16) * 0.2)(B, S, D)),
            "v": _w((lambda *s: torch.randn(*s, dtype=torch.bfloat16) * 0.2)(B, S, D)),
            "shift_k": _w((lambda *s: torch.randn(*s, dtype=torch.bfloat16) * 0.2)(D, ks) * 0.5),
            "ssm_k": _w((lambda *s: torch.randn(*s, dtype=torch.bfloat16) * 0.2)(D, S) * (1.0 / S ** 0.5)),
            "ssm_D": _w((lambda *s: torch.randn(*s, dtype=torch.bfloat16) * 0.2)(D)),
        }
    _A_in = _A_setup()

    def _B_setup():
        B, S, D, F = 1, 2048, 448, 1792
        return {
            "x": _w((lambda *s: torch.randn(*s, dtype=torch.bfloat16) * 0.05)(B, S, D)),
            "w1": _w((lambda *s: torch.randn(*s, dtype=torch.bfloat16) * 0.1)(D, F)),
            "b1": _w((lambda *s: torch.randn(*s, dtype=torch.bfloat16) * 0.4)(F)),
            "w2": _w((lambda *s: torch.randn(*s, dtype=torch.bfloat16) * 0.1)(F, D)),
            "b2": _w((lambda *s: torch.randn(*s, dtype=torch.bfloat16) * 12.8)(D)),
        }
    _B_in = _B_setup()

    return {
        "A_q": _A_in["q"],
        "A_k": _A_in["k"],
        "A_v": _A_in["v"],
        "A_shift_k": _A_in["shift_k"],
        "A_ssm_k": _A_in["ssm_k"],
        "A_ssm_D": _A_in["ssm_D"],
        "B_x": _B_in["x"],
        "B_w1": _B_in["w1"],
        "B_b1": _B_in["b1"],
        "B_w2": _B_in["w2"],
        "B_b2": _B_in["b2"],
    }

def reference(A_q, A_k, A_v, A_shift_k, A_ssm_k, A_ssm_D, B_x, B_w1, B_b1, B_w2, B_b2):
    def _A_ref(q, k, v, shift_k, ssm_k, ssm_D):
        B, S, D = q.shape
        ks = shift_k.shape[-1]
        k_pad = _pad(k, ((0, 0), (ks - 1, 0), (0, 0)))
        k_shift = torch.zeros_like(k)
        for t in range(ks):
            k_shift = k_shift + k_pad[:, t:t + S, :] * shift_k[:, ks - 1 - t][None, None, :]
        kv = k_shift * v
        L = 2 * S
        kv_pad = _pad(kv, ((0, 0), (0, S), (0, 0)))
        kf_pad = _pad(ssm_k, ((0, 0), (0, S)))
        kv_f = (lambda x, axes=(-2,-1): torch.fft.rfft2(x.float(), dim=axes))(kv_pad[:, None, :, :], axes=(1, 2))
        kf_f = (lambda x, axes=(-2,-1): torch.fft.rfft2(x.float(), dim=axes))(kf_pad[:, None, :], axes=(1, 2))
        kf_f = (lambda x, *d: x.permute(*d))(kf_f, 1, 2, 0)
        y_f = kv_f * kf_f[None, :, :, :]
        y = (lambda x, s, axes=(-2,-1): torch.fft.irfft2(x, s=s, dim=axes).to(torch.bfloat16))(y_f, (1, L), axes=(1, 2))[:, 0, :S, :]
        y = y + kv * ssm_D[None, None, :]
        return q * y

    def _B_ref(x, w1, b1, w2, b2):
        h = torch.einsum("bsd,df->bsf", x, w1) + b1
        zero = torch.zeros_like(h)
        r = torch.where(h > zero, h, zero)
        h = r * r
        out = torch.einsum("bsf,fd->bsd", h, w2) + b2
        return out

    x = A_q
    xn = _layernorm(x, axis=-1)
    s = _A_ref(xn, A_k, A_v, A_shift_k, A_ssm_k, A_ssm_D)
    g = _silu(_B_ref(xn, B_w1, B_b1, B_w2, B_b2))
    return x + s * g
```

```asm
; @launch grid=(254,1,1) block=(256,1,1) lds=163840
.amdgcn_target "amdgcn-amd-amdhsa--gfx950"
.text
.globl recurrent_scan__ssm_conv_h3__dense_activation_squared_relu__prompt_kernel
.p2align 8
.type recurrent_scan__ssm_conv_h3__dense_activation_squared_relu__prompt_kernel,@function
recurrent_scan__ssm_conv_h3__dense_activation_squared_relu__prompt_kernel:
    s_load_dwordx2 s[60:61], s[0:1], 8
    s_load_dwordx2 s[64:65], s[0:1], 16
    s_load_dwordx2 s[16:17], s[0:1], 24
    s_load_dwordx2 s[44:45], s[0:1], 0
    s_load_dwordx2 s[48:49], s[0:1], 56
    v_and_b32 v1, 63, v0
    v_lshrrev_b32 v176, 6, v0
    v_lshrrev_b32 v180, 3, v1
    v_readfirstlane_b32 s3, v176
    v_mul_u32_u24 v176, 896, v180
    v_and_b32 v177, 7, v1
    s_sub_u32 s95, s2, 30
    s_cbranch_scc1 L_helper
    s_cmp_ge_u32 s95, 224
    s_cbranch_scc1 L_end
    s_and_b32 s24, s95, 7
    s_lshr_b32 s25, s95, 3
    s_mul_i32 s26, s25, 37
    s_lshr_b32 s5, s26, 8
    s_mul_i32 s27, s5, 7
    s_sub_u32 s9, s25, s27
    s_lshl_b32 s27, s24, 2
    s_add_u32 s8, s27, s5
    v_and_b32 v178, 2, v180
    v_lshlrev_b32 v178, 1, v178
    v_xor_b32 v179, v177, v178
    v_lshl_add_u32 v12, v179, 4, v176
    v_add_u32 v13, 6144, v12
    s_lshl_b32 s26, s8, 2
    s_add_u32 s26, s26, s3
    s_mul_i32 s27, s26, 14336
    s_lshl_b32 s25, s9, 7
    s_add_u32 s27, s27, s25
    s_sub_u32 s25, s27, 7168
    s_cmp_eq_u32 s26, 0
    s_cselect_b32 s26, 0x7fff0000, s25
    s_mul_i32 s42, s3, 5120
    s_add_u32 s42, s42, 139264
    s_mov_b32 s62, 1835008
    s_mov_b32 s63, 0x20000
    s_mov_b32 s66, 1835008
    s_mov_b32 s67, 0x20000
    s_mov_b32 m0, s42
    s_lshl_b32 s25, s9, 9
    v_lshl_add_u32 v182, v1, 3, s25
    s_waitcnt lgkmcnt(0)
    buffer_load_dwordx4 v12, s[60:63], s26 offen lds
    s_add_u32 m0, s42, 1024
    global_load_dwordx2 v[184:185], v182, s[16:17]
    buffer_load_dwordx4 v12, s[60:63], s27 offen lds
    buffer_load_dwordx4 v13, s[60:63], s27 offen offset:1024 lds
    s_add_u32 m0, s42, 3072
    s_lshr_b32 s26, s24, 1
    buffer_load_dwordx4 v12, s[64:67], s27 offen lds
    buffer_load_dwordx4 v13, s[64:67], s27 offen offset:1024 lds
    s_load_dwordx2 s[18:19], s[0:1], 40
    s_load_dwordx2 s[76:77], s[0:1], 96
    s_load_dwordx2 s[56:57], s[0:1], 104
    s_load_dwordx2 s[52:53], s[0:1], 72
    s_load_dwordx2 s[68:69], s[0:1], 32
    s_load_dwordx2 s[22:23], s[0:1], 80
    s_load_dwordx2 s[72:73], s[0:1], 88
    s_lshl_b32 s26, s26, 2
    s_add_u32 s6, s26, s5
    s_and_b32 s27, s24, 1
    s_mul_i32 s27, s27, 7
    s_add_u32 s7, s27, s9
    s_mov_b32 s46, 1835008
    s_mov_b32 s47, 0x20000
    s_mov_b32 s50, 1605632
    s_mov_b32 s51, 0x20000
    v_lshrrev_b32 v178, 1, v180
    v_xor_b32 v179, v177, v178
    v_lshl_add_u32 v4, v179, 4, v176
    v_xor_b32 v5, 64, v4
    v_add_u32 v5, 6144, v5
    v_add_u32 v6, 12288, v4
    v_add_u32 v7, 12288, v5
    v_lshrrev_b32 v28, 4, v1
    v_mul_u32_u24 v178, 3584, v28
    v_and_b32 v179, 15, v1
    v_lshlrev_b32 v183, 2, v28
    v_xor_b32 v179, v179, v183
    v_lshl_add_u32 v8, v179, 4, v178
    v_add_u32 v9, 13312, v8
    v_add_u32 v10, 26624, v8
    v_add_u32 v11, 39936, v8
    s_lshl_b32 s26, s6, 2
    s_add_u32 s26, s26, s3
    s_mul_i32 s12, s26, 28672
    s_mul_i32 s13, s3, 57344
    s_lshl_b32 s26, s7, 8
    s_add_u32 s13, s13, s26
    s_lshl_b32 s30, s3, 12
    s_add_u32 s31, s30, 16384
    s_add_u32 m0, s30, 0
    s_nop 0
    buffer_load_dwordx4 v4, s[44:47], s12 offen offset:0 lds
    buffer_load_dwordx4 v5, s[44:47], s12 offen offset:1024 lds
    buffer_load_dwordx4 v6, s[44:47], s12 offen offset:2048 lds
    buffer_load_dwordx4 v7, s[44:47], s12 offen offset:3072 lds
    s_add_u32 m0, s31, 0
    s_add_u32 s12, s12, 128
    buffer_load_dwordx4 v8, s[48:51], s13 offen offset:0 lds
    buffer_load_dwordx4 v9, s[48:51], s13 offen offset:1024 lds
    buffer_load_dwordx4 v10, s[48:51], s13 offen offset:2048 lds
    buffer_load_dwordx4 v11, s[48:51], s13 offen offset:3072 lds
    s_mov_b32 s4, 0xffff0000
    v_bfe_u32 v29, v1, 2, 2
    v_and_b32 v30, 3, v1
    s_lshl_b32 s25, s9, 7
    v_lshl_add_u32 v183, v1, 1, s25
    v_lshlrev_b32 v176, 1, v28
    v_lshrrev_b32 v177, 1, v30
    v_add_u32 v176, v176, v177
    v_and_b32 v177, 2, v29
    v_lshlrev_b32 v177, 1, v177
    v_xor_b32 v176, v176, v177
    v_lshlrev_b32 v176, 4, v176
    v_lshl_add_u32 v176, v29, 7, v176
    v_and_b32 v177, 1, v30
    v_lshl_add_u32 v38, v177, 3, v176
    v_add_u32 v187, s42, v38
    s_waitcnt lgkmcnt(0)
    global_load_ushort v33, v183, s[18:19]
    s_lshl_b32 s26, s95, 2
    s_add_u32 s26, s26, s3
    s_lshl_b32 s26, s26, 11
    v_lshl_add_u32 v183, v1, 4, s26
    global_load_dwordx4 v[168:171], v183, s[68:69]
    global_load_dwordx4 v[172:175], v183, s[68:69] offset:1024
    s_lshr_b32 s10, s3, 1
    s_and_b32 s11, s3, 1
    v_mov_b32 v252, 0
    v_mov_b32 v253, 0
    s_add_u32 m0, s30, 32768
    s_add_u32 s13, s13, 229376
    buffer_load_dwordx4 v4, s[44:47], s12 offen offset:0 lds
    v_mov_b32 v254, 0
    v_mov_b32 v255, 0
    v_and_b32 v177, 31, v1
    v_lshrrev_b32 v178, 5, v1
    buffer_load_dwordx4 v5, s[44:47], s12 offen offset:1024 lds
    v_bfe_u32 v179, v1, 1, 3
    v_xor_b32 v178, v178, v179
    v_lshlrev_b32 v178, 4, v178
    v_lshl_add_u32 v177, v177, 7, v178
    buffer_load_dwordx4 v6, s[44:47], s12 offen offset:2048 lds
    s_lshl_b32 s26, s10, 13
    v_add_u32 v16, s26, v177
    v_xor_b32 v17, 32, v16
    v_xor_b32 v18, 64, v16
    buffer_load_dwordx4 v7, s[44:47], s12 offen offset:3072 lds
    v_xor_b32 v19, 96, v16
    s_lshl_b32 s26, s11, 1
    v_xor_b32 v177, s26, v29
    v_lshlrev_b32 v177, 6, v177
    s_add_u32 m0, s31, 32768
    s_add_u32 s12, s12, 128
    buffer_load_dwordx4 v8, s[48:51], s13 offen offset:0 lds
    v_lshl_add_u32 v177, v29, 8, v177
    v_lshrrev_b32 v178, 1, v28
    v_lshl_add_u32 v177, v178, 11, v177
    v_and_b32 v178, 1, v28
    buffer_load_dwordx4 v9, s[48:51], s13 offen offset:1024 lds
    v_lshl_add_u32 v177, v178, 5, v177
    v_lshl_add_u32 v177, v30, 3, v177
    v_add_u32 v24, 16384, v177
    v_xor_b32 v25, 64, v24
    buffer_load_dwordx4 v10, s[48:51], s13 offen offset:2048 lds
    v_mfma_f32_32x32x16_bf16 v[48:63], v[252:255], v[252:255], 0
    v_mfma_f32_32x32x16_bf16 v[64:79], v[252:255], v[252:255], 0
    v_mfma_f32_32x32x16_bf16 v[80:95], v[252:255], v[252:255], 0
    v_mfma_f32_32x32x16_bf16 v[96:111], v[252:255], v[252:255], 0
    buffer_load_dwordx4 v11, s[48:51], s13 offen offset:3072 lds
    v_bfe_u32 v144, v1, 1, 2
    v_mul_u32_u24 v144, 5120, v144
    v_lshrrev_b32 v145, 3, v1
    v_lshl_add_u32 v144, v145, 5, v144
    v_and_b32 v146, 1, v1
    v_lshl_add_u32 v144, v146, 4, v144
    s_lshl_b32 s26, s3, 9
    s_add_u32 s26, s26, 139264
    v_add_u32 v144, s26, v144
    s_waitcnt vmcnt(19)
    ds_read_b64_tr_b16 v[188:189], v187 offset:512
    ds_read_b64_tr_b16 v[190:191], v187 offset:1024
    ds_read_b64_tr_b16 v[192:193], v187 offset:1536
    ds_read_b64_tr_b16 v[194:195], v187 offset:2048
    ds_read_b64_tr_b16 v[196:197], v187 offset:2560
    ds_read_b64_tr_b16 v[198:199], v187 offset:3072
    ds_read_b64_tr_b16 v[200:201], v187 offset:3584
    ds_read_b64_tr_b16 v[202:203], v187 offset:4096
    ds_read_b64_tr_b16 v[204:205], v187 offset:4608
    v_alignbit_b32 v176, v184, v184, 16
    v_alignbit_b32 v177, v185, v185, 16
    v_and_b32 v178, 0xffff, v184
    v_and_b32 v182, s4, v185
    v_bfi_b32 v179, s4, v184, v185
    s_waitcnt lgkmcnt(4)
    v_dot2_f32_bf16 v206, v190, v178, 0
    v_dot2_f32_bf16 v207, v190, v176, 0
    v_dot2_f32_bf16 v208, v191, v178, 0
    s_add_u32 m0, s30, 65536
    s_add_u32 s13, s13, 229376
    buffer_load_dwordx4 v4, s[44:47], s12 offen offset:0 lds
    v_dot2_f32_bf16 v209, v191, v176, 0
    v_dot2_f32_bf16 v210, v192, v178, 0
    v_dot2_f32_bf16 v211, v192, v176, 0
    v_dot2_f32_bf16 v212, v193, v178, 0
    v_dot2_f32_bf16 v213, v193, v176, 0
    v_dot2_f32_bf16 v214, v194, v178, 0
    v_dot2_f32_bf16 v215, v194, v176, 0
    v_dot2_f32_bf16 v216, v195, v178, 0
    v_dot2_f32_bf16 v217, v195, v176, 0
    buffer_load_dwordx4 v5, s[44:47], s12 offen offset:1024 lds
    v_dot2_f32_bf16 v218, v196, v178, 0
    v_dot2_f32_bf16 v219, v196, v176, 0
    v_dot2_f32_bf16 v220, v197, v178, 0
    v_dot2_f32_bf16 v221, v197, v176, 0
    v_dot2c_f32_bf16 v206, v189, v179
    v_dot2c_f32_bf16 v207, v189, v177
    v_dot2c_f32_bf16 v208, v190, v179
    v_dot2c_f32_bf16 v209, v190, v177
    v_dot2c_f32_bf16 v210, v191, v179
    buffer_load_dwordx4 v6, s[44:47], s12 offen offset:2048 lds
    v_dot2c_f32_bf16 v211, v191, v177
    v_dot2c_f32_bf16 v212, v192, v179
    v_dot2c_f32_bf16 v213, v192, v177
    v_dot2c_f32_bf16 v214, v193, v179
    v_dot2c_f32_bf16 v215, v193, v177
    v_dot2c_f32_bf16 v216, v194, v179
    v_dot2c_f32_bf16 v217, v194, v177
    v_dot2c_f32_bf16 v218, v195, v179
    v_dot2c_f32_bf16 v219, v195, v177
    buffer_load_dwordx4 v7, s[44:47], s12 offen offset:3072 lds
    v_dot2c_f32_bf16 v220, v196, v179
    v_dot2c_f32_bf16 v221, v196, v177
    v_dot2c_f32_bf16 v206, v188, v182
    v_dot2c_f32_bf16 v208, v189, v182
    v_dot2c_f32_bf16 v210, v190, v182
    v_dot2c_f32_bf16 v212, v191, v182
    v_dot2c_f32_bf16 v214, v192, v182
    v_dot2c_f32_bf16 v216, v193, v182
    v_dot2c_f32_bf16 v218, v194, v182
    s_add_u32 m0, s31, 65536
    s_add_u32 s12, s12, 128
    buffer_load_dwordx4 v8, s[48:51], s13 offen offset:0 lds
    v_dot2c_f32_bf16 v220, v195, v182
    s_waitcnt lgkmcnt(0)
    v_lshlrev_b32 v222, 16, v198
    v_and_b32 v223, s4, v198
    v_lshlrev_b32 v224, 16, v199
    v_and_b32 v225, s4, v199
    v_lshlrev_b32 v226, 16, v200
    v_and_b32 v227, s4, v200
    v_lshlrev_b32 v228, 16, v201
    buffer_load_dwordx4 v9, s[48:51], s13 offen offset:1024 lds
    v_and_b32 v229, s4, v201
    v_lshlrev_b32 v230, 16, v202
    v_and_b32 v231, s4, v202
    v_lshlrev_b32 v232, 16, v203
    v_and_b32 v233, s4, v203
    v_lshlrev_b32 v234, 16, v204
    v_and_b32 v235, s4, v204
    v_lshlrev_b32 v236, 16, v205
    v_and_b32 v237, s4, v205
    buffer_load_dwordx4 v10, s[48:51], s13 offen offset:2048 lds
    v_pk_mul_f32 v[206:207], v[206:207], v[222:223]
    v_pk_mul_f32 v[208:209], v[208:209], v[224:225]
    v_pk_mul_f32 v[210:211], v[210:211], v[226:227]
    v_pk_mul_f32 v[212:213], v[212:213], v[228:229]
    v_pk_mul_f32 v[214:215], v[214:215], v[230:231]
    v_pk_mul_f32 v[216:217], v[216:217], v[232:233]
    v_pk_mul_f32 v[218:219], v[218:219], v[234:235]
    v_pk_mul_f32 v[220:221], v[220:221], v[236:237]
    v_cvt_pk_bf16_f32 v188, v206, v210
    buffer_load_dwordx4 v11, s[48:51], s13 offen offset:3072 lds
    v_cvt_pk_bf16_f32 v189, v214, v218
    v_cvt_pk_bf16_f32 v190, v207, v211
    v_cvt_pk_bf16_f32 v191, v215, v219
    v_cvt_pk_bf16_f32 v192, v208, v212
    v_cvt_pk_bf16_f32 v193, v216, v220
    v_cvt_pk_bf16_f32 v194, v209, v213
    v_cvt_pk_bf16_f32 v195, v217, v221
    v_lshl_add_u32 v176, v1, 5, s42
    ds_write_b128 v176, v[188:191]
    ds_write_b128 v176, v[192:195] offset:16
    s_waitcnt vmcnt(19)
    s_waitcnt lgkmcnt(0)
    s_barrier
    ds_read_b128 v[112:115], v16 offset:0
    ds_read_b64_tr_b16 v[120:121], v24 offset:0
    ds_read_b64_tr_b16 v[122:123], v24 offset:1024
    ds_read_b128 v[116:119], v16 offset:4096
    ds_read_b64_tr_b16 v[124:125], v25 offset:0
    ds_read_b64_tr_b16 v[126:127], v25 offset:1024
    ds_read_b128 v[148:151], v144
    ds_read_b128 v[152:155], v144 offset:256
    s_waitcnt lgkmcnt(5)
    v_mfma_f32_32x32x16_bf16 v[48:63], v[120:123], v[112:115], v[48:63]
    ds_read_b128 v[128:131], v17 offset:0
    ds_read_b64_tr_b16 v[136:137], v24 offset:4096
    s_mov_b32 s58, 268435456
    s_mov_b32 s59, 0x20000
    s_waitcnt lgkmcnt(6)
    v_mfma_f32_32x32x16_bf16 v[64:79], v[120:123], v[116:119], v[64:79]
    ds_read_b64_tr_b16 v[138:139], v24 offset:5120
    s_add_u32 m0, s30, 98304
    s_add_u32 s13, s13, 229376
    buffer_load_dwordx4 v4, s[44:47], s12 offen offset:0 lds
    v_and_b32 v146, 7, v1
    v_lshlrev_b32 v146, 4, v146
    s_waitcnt lgkmcnt(5)
    v_mfma_f32_32x32x16_bf16 v[80:95], v[124:127], v[112:115], v[80:95]
    ds_read_b128 v[132:135], v17 offset:4096
    ds_read_b64_tr_b16 v[140:141], v25 offset:4096
    v_lshl_add_u32 v146, v145, 12, v146
    s_lshl_b32 s26, s9, 2
    v_mfma_f32_32x32x16_bf16 v[96:111], v[124:127], v[116:119], v[96:111]
    ds_read_b64_tr_b16 v[142:143], v25 offset:5120
    buffer_load_dwordx4 v5, s[44:47], s12 offen offset:1024 lds
    s_add_u32 s26, s26, s3
    s_lshl_b32 s26, s26, 16
    s_waitcnt lgkmcnt(3)
    v_mfma_f32_32x32x16_bf16 v[48:63], v[136:139], v[128:131], v[48:63]
    ds_read_b128 v[112:115], v18 offset:0
    ds_read_b64_tr_b16 v[120:121], v24 offset:8192
    s_lshl_b32 s27, s8, 7
    s_add_u32 s26, s26, s27
    s_waitcnt lgkmcnt(4)
    v_mfma_f32_32x32x16_bf16 v[64:79], v[136:139], v[132:135], v[64:79]
    ds_read_b64_tr_b16 v[122:123], v24 offset:9216
    buffer_load_dwordx4 v6, s[44:47], s12 offen offset:2048 lds
    s_add_u32 s26, s26, 1048576
    s_add_u32 s27, s26, 32768
    s_waitcnt lgkmcnt(3)
    v_mfma_f32_32x32x16_bf16 v[80:95], v[140:143], v[128:131], v[80:95]
    ds_read_b128 v[116:119], v18 offset:4096
    ds_read_b64_tr_b16 v[124:125], v25 offset:8192
    buffer_store_dwordx4 v[148:151], v146, s[56:59], s26 offen sc1
    v_mfma_f32_32x32x16_bf16 v[96:111], v[140:143], v[132:135], v[96:111]
    ds_read_b64_tr_b16 v[126:127], v25 offset:9216
    buffer_load_dwordx4 v7, s[44:47], s12 offen offset:3072 lds
    buffer_store_dwordx4 v[152:155], v146, s[56:59], s27 offen sc1
    s_mov_b32 s78, 256
    s_waitcnt lgkmcnt(3)
    v_mfma_f32_32x32x16_bf16 v[48:63], v[120:123], v[112:115], v[48:63]
    ds_read_b128 v[128:131], v19 offset:0
    ds_read_b64_tr_b16 v[136:137], v24 offset:12288
    s_mov_b32 s79, 0x20000
    v_mov_b32 v31, 0
    s_waitcnt lgkmcnt(4)
    v_mfma_f32_32x32x16_bf16 v[64:79], v[120:123], v[116:119], v[64:79]
    ds_read_b64_tr_b16 v[138:139], v24 offset:13312
    s_add_u32 m0, s31, 98304
    s_add_u32 s12, s12, 128
    buffer_load_dwordx4 v8, s[48:51], s13 offen offset:0 lds
    buffer_load_dword v32, v31, s[76:79], 0 offen sc1
    v_add_u32 v20, 65536, v16
    s_waitcnt lgkmcnt(3)
    v_mfma_f32_32x32x16_bf16 v[80:95], v[124:127], v[112:115], v[80:95]
    ds_read_b128 v[132:135], v19 offset:4096
    ds_read_b64_tr_b16 v[140:141], v25 offset:12288
    v_add_u32 v21, 65536, v17
    v_add_u32 v22, 65536, v18
    v_mfma_f32_32x32x16_bf16 v[96:111], v[124:127], v[116:119], v[96:111]
    ds_read_b64_tr_b16 v[142:143], v25 offset:13312
    buffer_load_dwordx4 v9, s[48:51], s13 offen offset:1024 lds
    v_add_u32 v23, 65536, v19
    v_add_u32 v26, 65536, v24
    s_waitcnt lgkmcnt(3)
    v_mfma_f32_32x32x16_bf16 v[48:63], v[136:139], v[128:131], v[48:63]
    buffer_load_dwordx4 v10, s[48:51], s13 offen offset:2048 lds
    v_add_u32 v27, 65536, v25
    s_mov_b32 s40, 200000
    s_lshl_b32 s5, s9, 7
    s_waitcnt lgkmcnt(2)
    v_mfma_f32_32x32x16_bf16 v[64:79], v[136:139], v[132:135], v[64:79]
    s_waitcnt vmcnt(18)
    s_waitcnt lgkmcnt(0)
    s_barrier
    ds_read_b128 v[112:115], v16 offset:32768
    ds_read_b64_tr_b16 v[120:121], v24 offset:32768
    ds_read_b64_tr_b16 v[122:123], v24 offset:33792
    v_mfma_f32_32x32x16_bf16 v[80:95], v[140:143], v[128:131], v[80:95]
    ds_read_b128 v[116:119], v16 offset:36864
    ds_read_b64_tr_b16 v[124:125], v25 offset:32768
    ds_read_b64_tr_b16 v[126:127], v25 offset:33792
    v_mfma_f32_32x32x16_bf16 v[96:111], v[140:143], v[132:135], v[96:111]
    buffer_load_dwordx4 v11, s[48:51], s13 offen offset:3072 lds
    s_lshl_b32 s83, s8, 2
    s_add_u32 s83, s83, s5
    s_cmp_eq_u32 s3, 0
    s_cselect_b32 s83, s83, 0x7fff0000
    s_waitcnt lgkmcnt(3)
    v_mfma_f32_32x32x16_bf16 v[48:63], v[120:123], v[112:115], v[48:63]
    ds_read_b128 v[128:131], v17 offset:32768
    ds_read_b64_tr_b16 v[136:137], v24 offset:36864
    s_mov_b32 s74, 1835008
    s_mov_b32 s75, 0x20000
    s_waitcnt lgkmcnt(4)
    v_mfma_f32_32x32x16_bf16 v[64:79], v[120:123], v[116:119], v[64:79]
    ds_read_b64_tr_b16 v[138:139], v24 offset:37888
    s_add_u32 m0, s30, 0
    s_add_u32 s13, s13, 229376
    buffer_load_dwordx4 v4, s[44:47], s12 offen offset:0 lds
    s_mov_b32 s54, 1605632
    s_mov_b32 s55, 0x20000
    s_waitcnt lgkmcnt(3)
    v_mfma_f32_32x32x16_bf16 v[80:95], v[124:127], v[112:115], v[80:95]
    ds_read_b128 v[132:135], v17 offset:36864
    ds_read_b64_tr_b16 v[140:141], v25 offset:36864
    v_lshlrev_b32 v2, 4, v1
    s_lshl_b32 s96, s95, 1
    v_mfma_f32_32x32x16_bf16 v[96:111], v[124:127], v[116:119], v[96:111]
    ds_read_b64_tr_b16 v[142:143], v25 offset:37888
    buffer_load_dwordx4 v5, s[44:47], s12 offen offset:1024 lds
    s_add_u32 s96, s96, s10
    s_lshl_b32 s96, s96, 12
    s_waitcnt lgkmcnt(3)
    v_mfma_f32_32x32x16_bf16 v[48:63], v[136:139], v[128:131], v[48:63]
    ds_read_b128 v[112:115], v18 offset:32768
    ds_read_b64_tr_b16 v[120:121], v24 offset:40960
    s_mov_b32 s36, -1
    s_mov_b32 s37, 0
    s_waitcnt lgkmcnt(4)
    v_mfma_f32_32x32x16_bf16 v[64:79], v[136:139], v[132:135], v[64:79]
    ds_read_b64_tr_b16 v[122:123], v24 offset:41984
    buffer_load_dwordx4 v6, s[44:47], s12 offen offset:2048 lds
    v_add_u32 v14, 12288, v12
    v_add_u32 v15, 18432, v12
    s_waitcnt lgkmcnt(3)
    v_mfma_f32_32x32x16_bf16 v[80:95], v[140:143], v[128:131], v[80:95]
    ds_read_b128 v[116:119], v18 offset:36864
    ds_read_b64_tr_b16 v[124:125], v25 offset:40960
    s_lshl_b32 s41, s3, 13
    s_and_b32 s26, s8, 3
    v_mfma_f32_32x32x16_bf16 v[96:111], v[140:143], v[132:135], v[96:111]
    ds_read_b64_tr_b16 v[126:127], v25 offset:41984
    buffer_load_dwordx4 v7, s[44:47], s12 offen offset:3072 lds
    s_lshl_b32 s26, s26, 1
    s_add_u32 s100, s26, s9
    s_waitcnt lgkmcnt(3)
    v_mfma_f32_32x32x16_bf16 v[48:63], v[120:123], v[112:115], v[48:63]
    ds_read_b128 v[128:131], v19 offset:32768
    ds_read_b64_tr_b16 v[136:137], v24 offset:45056
    s_sub_u32 s26, s100, 7
    s_cmp_ge_u32 s100, 7
    s_cselect_b32 s100, s26, s100
    s_waitcnt lgkmcnt(4)
    v_mfma_f32_32x32x16_bf16 v[64:79], v[120:123], v[116:119], v[64:79]
    ds_read_b64_tr_b16 v[138:139], v24 offset:46080
    s_add_u32 m0, s31, 0
    s_add_u32 s12, s12, 128
    buffer_load_dwordx4 v8, s[48:51], s13 offen offset:0 lds
    s_mul_i32 s14, s3, 401408
    s_lshl_b32 s26, s9, 7
    s_waitcnt lgkmcnt(3)
    v_mfma_f32_32x32x16_bf16 v[80:95], v[124:127], v[112:115], v[80:95]
    ds_read_b128 v[132:135], v19 offset:36864
    ds_read_b64_tr_b16 v[140:141], v25 offset:45056
    s_add_u32 s14, s14, s26
    s_add_u32 s101, s14, 401408
    v_mfma_f32_32x32x16_bf16 v[96:111], v[124:127], v[116:119], v[96:111]
    ds_read_b64_tr_b16 v[142:143], v25 offset:46080
    buffer_load_dwordx4 v9, s[48:51], s13 offen offset:1024 lds
    s_mul_i32 s26, s100, 57344
    s_add_u32 s14, s14, s26
    s_waitcnt lgkmcnt(3)
    v_mfma_f32_32x32x16_bf16 v[48:63], v[136:139], v[128:131], v[48:63]
    buffer_load_dwordx4 v10, s[48:51], s13 offen offset:2048 lds
    v_lshlrev_b32 v33, 16, v33
    s_lshl_b32 s26, s3, 11
    s_waitcnt lgkmcnt(2)
    v_mfma_f32_32x32x16_bf16 v[64:79], v[136:139], v[132:135], v[64:79]
    s_waitcnt vmcnt(10)
    s_waitcnt lgkmcnt(0)
    s_barrier
    ds_read_b128 v[112:115], v20 offset:0
    ds_read_b64_tr_b16 v[120:121], v26 offset:0
    ds_read_b64_tr_b16 v[122:123], v26 offset:1024
    v_mfma_f32_32x32x16_bf16 v[80:95], v[140:143], v[128:131], v[80:95]
    ds_read_b128 v[116:119], v20 offset:4096
    ds_read_b64_tr_b16 v[124:125], v27 offset:0
    ds_read_b64_tr_b16 v[126:127], v27 offset:1024
    v_mfma_f32_32x32x16_bf16 v[96:111], v[140:143], v[132:135], v[96:111]
    buffer_load_dwordx4 v11, s[48:51], s13 offen offset:3072 lds
    s_add_u32 s26, s26, 131072
    v_lshl_add_u32 v176, v1, 5, s26
    v_mul_f32 v206, v206, v33
    s_waitcnt lgkmcnt(3)
    v_mfma_f32_32x32x16_bf16 v[48:63], v[120:123], v[112:115], v[48:63]
    ds_read_b128 v[128:131], v21 offset:0
    ds_read_b64_tr_b16 v[136:137], v26 offset:4096
L_ctokm:
    v_readfirstlane_b32 s32, v32
    s_cmp_eq_u32 s32, 0
    s_cbranch_scc1 L_stokm
L_rtokm:
    buffer_store_dword v32, v31, s[56:59], s83 offen sc1
    v_mul_f32 v207, v207, v33
    s_waitcnt lgkmcnt(4)
    v_mfma_f32_32x32x16_bf16 v[64:79], v[120:123], v[116:119], v[64:79]
    ds_read_b64_tr_b16 v[138:139], v26 offset:5120
    s_add_u32 m0, s30, 32768
    s_add_u32 s13, s13, 229376
    buffer_load_dwordx4 v4, s[44:47], s12 offen offset:0 lds
    v_mul_f32 v208, v208, v33
    v_mul_f32 v209, v209, v33
    s_waitcnt lgkmcnt(3)
    v_mfma_f32_32x32x16_bf16 v[80:95], v[124:127], v[112:115], v[80:95]
    ds_read_b128 v[132:135], v21 offset:4096
    ds_read_b64_tr_b16 v[140:141], v27 offset:4096
    v_mul_f32 v210, v210, v33
    v_mul_f32 v211, v211, v33
    v_mfma_f32_32x32x16_bf16 v[96:111], v[124:127], v[116:119], v[96:111]
    ds_read_b64_tr_b16 v[142:143], v27 offset:5120
    buffer_load_dwordx4 v5, s[44:47], s12 offen offset:1024 lds
    v_mul_f32 v212, v212, v33
    v_mul_f32 v213, v213, v33
    s_waitcnt lgkmcnt(3)
    v_mfma_f32_32x32x16_bf16 v[48:63], v[136:139], v[128:131], v[48:63]
    ds_read_b128 v[112:115], v22 offset:0
    ds_read_b64_tr_b16 v[120:121], v26 offset:8192
    v_mul_f32 v214, v214, v33
    v_mul_f32 v215, v215, v33
    s_waitcnt lgkmcnt(4)
    v_mfma_f32_32x32x16_bf16 v[64:79], v[136:139], v[132:135], v[64:79]
    ds_read_b64_tr_b16 v[122:123], v26 offset:9216
    buffer_load_dwordx4 v6, s[44:47], s12 offen offset:2048 lds
    v_mul_f32 v216, v216, v33
    v_mul_f32 v217, v217, v33
    s_waitcnt lgkmcnt(3)
    v_mfma_f32_32x32x16_bf16 v[80:95], v[140:143], v[128:131], v[80:95]
    ds_read_b128 v[116:119], v22 offset:4096
    ds_read_b64_tr_b16 v[124:125], v27 offset:8192
    v_mul_f32 v218, v218, v33
    v_mul_f32 v219, v219, v33
    v_mfma_f32_32x32x16_bf16 v[96:111], v[140:143], v[132:135], v[96:111]
    ds_read_b64_tr_b16 v[126:127], v27 offset:9216
    buffer_load_dwordx4 v7, s[44:47], s12 offen offset:3072 lds
    v_mul_f32 v220, v220, v33
    v_mul_f32 v221, v221, v33
    s_waitcnt lgkmcnt(3)
    v_mfma_f32_32x32x16_bf16 v[48:63], v[120:123], v[112:115], v[48:63]
    ds_read_b128 v[128:131], v23 offset:0
    ds_read_b64_tr_b16 v[136:137], v26 offset:12288
    v_cvt_pk_bf16_f32 v196, v206, v207
    v_cvt_pk_bf16_f32 v197, v208, v209
    s_waitcnt lgkmcnt(4)
    v_mfma_f32_32x32x16_bf16 v[64:79], v[120:123], v[116:119], v[64:79]
    ds_read_b64_tr_b16 v[138:139], v26 offset:13312
    s_add_u32 m0, s31, 32768
    s_add_u32 s12, s12, 128
    buffer_load_dwordx4 v8, s[48:51], s13 offen offset:0 lds
    v_cvt_pk_bf16_f32 v198, v210, v211
    v_cvt_pk_bf16_f32 v199, v212, v213
    s_waitcnt lgkmcnt(3)
    v_mfma_f32_32x32x16_bf16 v[80:95], v[124:127], v[112:115], v[80:95]
    ds_read_b128 v[132:135], v23 offset:4096
    ds_read_b64_tr_b16 v[140:141], v27 offset:12288
    v_cvt_pk_bf16_f32 v200, v214, v215
    v_cvt_pk_bf16_f32 v201, v216, v217
    v_mfma_f32_32x32x16_bf16 v[96:111], v[124:127], v[116:119], v[96:111]
    ds_read_b64_tr_b16 v[142:143], v27 offset:13312
    buffer_load_dwordx4 v9, s[48:51], s13 offen offset:1024 lds
    v_cvt_pk_bf16_f32 v202, v218, v219
    v_cvt_pk_bf16_f32 v203, v220, v221
    s_waitcnt lgkmcnt(3)
    v_mfma_f32_32x32x16_bf16 v[48:63], v[136:139], v[128:131], v[48:63]
    buffer_load_dwordx4 v10, s[48:51], s13 offen offset:2048 lds
    ds_write_b128 v176, v[196:199]
    ds_write_b128 v176, v[200:203] offset:16
    v_and_b32 v47, 31, v1
    s_waitcnt lgkmcnt(4)
    v_mfma_f32_32x32x16_bf16 v[64:79], v[136:139], v[132:135], v[64:79]
    s_waitcnt vmcnt(16)
    s_waitcnt lgkmcnt(0)
    s_barrier
    ds_read_b128 v[112:115], v20 offset:32768
    ds_read_b64_tr_b16 v[120:121], v26 offset:32768
    ds_read_b64_tr_b16 v[122:123], v26 offset:33792
    v_mfma_f32_32x32x16_bf16 v[80:95], v[140:143], v[128:131], v[80:95]
    ds_read_b128 v[116:119], v20 offset:36864
    ds_read_b64_tr_b16 v[124:125], v27 offset:32768
    ds_read_b64_tr_b16 v[126:127], v27 offset:33792
    v_mfma_f32_32x32x16_bf16 v[96:111], v[140:143], v[132:135], v[96:111]
    buffer_load_dwordx4 v11, s[48:51], s13 offen offset:3072 lds
    v_lshlrev_b32 v36, 2, v47
    v_lshlrev_b32 v47, 4, v47
    s_lshl_b32 s24, s6, 1
    s_waitcnt lgkmcnt(3)
    v_mfma_f32_32x32x16_bf16 v[48:63], v[120:123], v[112:115], v[48:63]
    ds_read_b128 v[128:131], v21 offset:32768
    ds_read_b64_tr_b16 v[136:137], v26 offset:36864
    s_add_u32 s24, s24, s10
    s_lshl_b32 s25, s7, 1
    s_waitcnt lgkmcnt(4)
    v_mfma_f32_32x32x16_bf16 v[64:79], v[120:123], v[116:119], v[64:79]
    ds_read_b64_tr_b16 v[138:139], v26 offset:37888
    s_add_u32 m0, s30, 65536
    s_add_u32 s13, s13, 229376
    buffer_load_dwordx4 v4, s[44:47], s12 offen offset:0 lds
    s_add_u32 s25, s25, s11
    s_lshl_b32 s80, s24, 10
    s_waitcnt lgkmcnt(3)
    v_mfma_f32_32x32x16_bf16 v[80:95], v[124:127], v[112:115], v[80:95]
    ds_read_b128 v[132:135], v21 offset:36864
    ds_read_b64_tr_b16 v[140:141], v27 offset:36864
    s_add_u32 s80, s80, 16384
    s_lshl_b32 s81, s25, 10
    v_mfma_f32_32x32x16_bf16 v[96:111], v[124:127], v[116:119], v[96:111]
    ds_read_b64_tr_b16 v[142:143], v27 offset:37888
    buffer_load_dwordx4 v5, s[44:47], s12 offen offset:1024 lds
    s_add_u32 s81, s81, 49152
    s_lshl_b32 s82, s8, 1
    s_waitcnt lgkmcnt(3)
    v_mfma_f32_32x32x16_bf16 v[48:63], v[136:139], v[128:131], v[48:63]
    ds_read_b128 v[112:115], v22 offset:32768
    ds_read_b64_tr_b16 v[120:121], v26 offset:40960
    s_add_u32 s82, s82, s11
    s_lshl_b32 s82, s82, 9
    s_waitcnt lgkmcnt(4)
    v_mfma_f32_32x32x16_bf16 v[64:79], v[136:139], v[132:135], v[64:79]
    ds_read_b64_tr_b16 v[122:123], v26 offset:41984
    buffer_load_dwordx4 v6, s[44:47], s12 offen offset:2048 lds
    s_add_u32 s82, s82, 16384
    s_lshr_b32 s83, s95, 5
    s_waitcnt lgkmcnt(3)
    v_mfma_f32_32x32x16_bf16 v[80:95], v[140:143], v[128:131], v[80:95]
    ds_read_b128 v[116:119], v22 offset:36864
    ds_read_b64_tr_b16 v[124:125], v27 offset:40960
    s_lshl_b32 s83, s83, 7
    s_mul_i32 s26, s3, 28
    v_mfma_f32_32x32x16_bf16 v[96:111], v[140:143], v[132:135], v[96:111]
    ds_read_b64_tr_b16 v[126:127], v27 offset:41984
    buffer_load_dwordx4 v7, s[44:47], s12 offen offset:3072 lds
    s_lshl_b32 s97, s8, 7
    s_add_u32 s97, s97, s26
    s_waitcnt lgkmcnt(3)
    v_mfma_f32_32x32x16_bf16 v[48:63], v[120:123], v[112:115], v[48:63]
    ds_read_b128 v[128:131], v23 offset:32768
    ds_read_b64_tr_b16 v[136:137], v26 offset:45056
    s_add_u32 s97, s97, 8192
    s_mul_i32 s34, s24, 229376
    s_waitcnt lgkmcnt(4)
    v_mfma_f32_32x32x16_bf16 v[64:79], v[120:123], v[116:119], v[64:79]
    ds_read_b64_tr_b16 v[138:139], v26 offset:46080
    s_add_u32 m0, s31, 65536
    s_add_u32 s12, s12, 128
    buffer_load_dwordx4 v8, s[48:51], s13 offen offset:0 lds
    s_lshl_b32 s26, s25, 12
    s_add_u32 s34, s34, s26
    s_waitcnt lgkmcnt(3)
    v_mfma_f32_32x32x16_bf16 v[80:95], v[124:127], v[112:115], v[80:95]
    ds_read_b128 v[132:135], v23 offset:36864
    ds_read_b64_tr_b16 v[140:141], v27 offset:45056
    s_add_u32 s34, s34, 5242880
    s_add_u32 s35, s34, 114688
    v_mfma_f32_32x32x16_bf16 v[96:111], v[124:127], v[116:119], v[96:111]
    ds_read_b64_tr_b16 v[142:143], v27 offset:46080
    buffer_load_dwordx4 v9, s[48:51], s13 offen offset:1024 lds
    s_lshl_b32 s98, s24, 7
    s_lshl_b32 s26, s25, 2
    s_waitcnt lgkmcnt(3)
    v_mfma_f32_32x32x16_bf16 v[48:63], v[136:139], v[128:131], v[48:63]
    buffer_load_dwordx4 v10, s[48:51], s13 offen offset:2048 lds
    s_add_u32 s98, s98, s26
    s_add_u32 s98, s98, 8192
    v_lshrrev_b32 v156, 1, v28
    s_waitcnt lgkmcnt(2)
    v_mfma_f32_32x32x16_bf16 v[64:79], v[136:139], v[132:135], v[64:79]
    s_waitcnt vmcnt(16)
    s_waitcnt lgkmcnt(0)
    s_barrier
    ds_read_b128 v[112:115], v16 offset:0
    ds_read_b64_tr_b16 v[120:121], v24 offset:0
    ds_read_b64_tr_b16 v[122:123], v24 offset:1024
    v_mfma_f32_32x32x16_bf16 v[80:95], v[140:143], v[128:131], v[80:95]
    ds_read_b128 v[116:119], v16 offset:4096
    ds_read_b64_tr_b16 v[124:125], v25 offset:0
    ds_read_b64_tr_b16 v[126:127], v25 offset:1024
    v_mfma_f32_32x32x16_bf16 v[96:111], v[140:143], v[132:135], v[96:111]
    buffer_load_dwordx4 v11, s[48:51], s13 offen offset:3072 lds
    v_xor_b32 v157, s10, v156
    v_lshlrev_b32 v157, 6, v157
    v_xor_b32 v38, v38, v157
    s_waitcnt lgkmcnt(3)
    v_mfma_f32_32x32x16_bf16 v[48:63], v[120:123], v[112:115], v[48:63]
    ds_read_b128 v[128:131], v17 offset:0
    ds_read_b64_tr_b16 v[136:137], v24 offset:4096
    v_lshl_add_u32 v38, v156, 9, v38
    v_add_u32 v38, s41, v38
    s_waitcnt lgkmcnt(4)
    v_mfma_f32_32x32x16_bf16 v[64:79], v[120:123], v[116:119], v[64:79]
    ds_read_b64_tr_b16 v[138:139], v24 offset:5120
    s_add_u32 m0, s41, 98304
    s_add_u32 s15, s14, 28672
    buffer_load_dwordx4 v12, s[52:55], s14 offen offset:0 lds
    v_xor_b32 v39, 64, v38
    v_add_u32 v40, 65536, v38
    s_waitcnt lgkmcnt(3)
    v_mfma_f32_32x32x16_bf16 v[80:95], v[124:127], v[112:115], v[80:95]
    ds_read_b128 v[132:135], v17 offset:4096
    ds_read_b64_tr_b16 v[140:141], v25 offset:4096
    v_add_u32 v41, 65536, v39
    v_lshl_add_u32 v156, v28, 1, v29
    v_mfma_f32_32x32x16_bf16 v[96:111], v[124:127], v[116:119], v[96:111]
    ds_read_b64_tr_b16 v[142:143], v25 offset:5120
    buffer_load_dwordx4 v13, s[52:55], s14 offen offset:1024 lds
    v_lshlrev_b32 v156, 5, v156
    v_lshl_add_u32 v156, v30, 3, v156
    s_waitcnt lgkmcnt(3)
    v_mfma_f32_32x32x16_bf16 v[48:63], v[136:139], v[128:131], v[48:63]
    ds_read_b128 v[112:115], v18 offset:0
    ds_read_b64_tr_b16 v[120:121], v24 offset:8192
    s_mul_i32 s24, s10, 4224
    s_add_u32 s24, s24, 139296
    s_waitcnt lgkmcnt(4)
    v_mfma_f32_32x32x16_bf16 v[64:79], v[136:139], v[132:135], v[64:79]
    ds_read_b64_tr_b16 v[122:123], v24 offset:9216
    buffer_load_dwordx4 v14, s[52:55], s14 offen offset:2048 lds
    v_add_u32 v42, s24, v156
    v_add_u32 v43, 2048, v42
    s_waitcnt lgkmcnt(3)
    v_mfma_f32_32x32x16_bf16 v[80:95], v[140:143], v[128:131], v[80:95]
    ds_read_b128 v[116:119], v18 offset:4096
    ds_read_b64_tr_b16 v[124:125], v25 offset:8192
    v_sub_u32 v156, v30, v29
    v_lshlrev_b32 v156, 3, v156
    v_mfma_f32_32x32x16_bf16 v[96:111], v[140:143], v[132:135], v[96:111]
    ds_read_b64_tr_b16 v[126:127], v25 offset:9216
    buffer_load_dwordx4 v15, s[52:55], s14 offen offset:3072 lds
    v_lshlrev_b32 v157, 6, v28
    v_sub_u32 v156, v156, v157
    s_waitcnt lgkmcnt(3)
    v_mfma_f32_32x32x16_bf16 v[48:63], v[120:123], v[112:115], v[48:63]
    ds_read_b128 v[128:131], v19 offset:0
    ds_read_b64_tr_b16 v[136:137], v24 offset:12288
    s_mul_i32 s24, s10, 4352
    s_lshl_b32 s25, s11, 7
    s_waitcnt lgkmcnt(4)
    v_mfma_f32_32x32x16_bf16 v[64:79], v[120:123], v[116:119], v[64:79]
    ds_read_b64_tr_b16 v[138:139], v24 offset:13312
    s_add_u32 m0, s41, 102400
    s_add_u32 s14, s14, 57344
    buffer_load_dwordx4 v12, s[52:55], s15 offen offset:0 lds
    s_cmp_eq_u32 s14, s101
    s_cselect_b32 s28, 401408, 0
    s_sub_u32 s14, s14, s28
    s_add_u32 s24, s24, s25
    s_add_u32 s24, s24, 148032
    s_waitcnt lgkmcnt(3)
    v_mfma_f32_32x32x16_bf16 v[80:95], v[124:127], v[112:115], v[80:95]
    ds_read_b128 v[132:135], v19 offset:4096
    ds_read_b64_tr_b16 v[140:141], v25 offset:12288
    v_add_u32 v44, s24, v156
    s_lshl_b32 s24, s10, 13
    v_mfma_f32_32x32x16_bf16 v[96:111], v[124:127], v[116:119], v[96:111]
    ds_read_b64_tr_b16 v[142:143], v25 offset:13312
    buffer_load_dwordx4 v13, s[52:55], s15 offen offset:1024 lds
    s_lshl_b32 s25, s11, 8
    s_add_u32 s25, s25, s24
    s_waitcnt lgkmcnt(3)
    v_mfma_f32_32x32x16_bf16 v[48:63], v[136:139], v[128:131], v[48:63]
    buffer_load_dwordx4 v14, s[52:55], s15 offen offset:2048 lds
    s_add_u32 s25, s25, 98304
    v_lshl_add_u32 v45, v1, 2, s25
    v_and_b32 v156, 1, v28
    s_waitcnt lgkmcnt(2)
    v_mfma_f32_32x32x16_bf16 v[64:79], v[136:139], v[132:135], v[64:79]
    s_waitcnt vmcnt(15)
    s_waitcnt lgkmcnt(0)
    s_barrier
    ds_read_b128 v[112:115], v16 offset:32768
    ds_read_b64_tr_b16 v[120:121], v24 offset:32768
    ds_read_b64_tr_b16 v[122:123], v24 offset:33792
    v_mfma_f32_32x32x16_bf16 v[80:95], v[140:143], v[128:131], v[80:95]
    ds_read_b128 v[116:119], v16 offset:36864
    ds_read_b64_tr_b16 v[124:125], v25 offset:32768
    ds_read_b64_tr_b16 v[126:127], v25 offset:33792
    v_mfma_f32_32x32x16_bf16 v[96:111], v[140:143], v[132:135], v[96:111]
    buffer_load_dwordx4 v15, s[52:55], s15 offen offset:3072 lds
    v_lshlrev_b32 v156, 1, v156
    v_lshrrev_b32 v157, 1, v28
    v_add_u32 v156, v156, v157
    s_waitcnt lgkmcnt(3)
    v_mfma_f32_32x32x16_bf16 v[48:63], v[120:123], v[112:115], v[48:63]
    ds_read_b128 v[128:131], v17 offset:32768
    ds_read_b64_tr_b16 v[136:137], v24 offset:36864
    buffer_load_dword v37, v36, s[56:59], s83 offen sc1
    buffer_load_dwordx4 v[176:179], v47, s[56:59], s80 offen sc1
    buffer_load_dwordx4 v[180:183], v47, s[56:59], s80 offen offset:512 sc1
    buffer_load_dwordx4 v[184:187], v47, s[56:59], s81 offen sc1
    buffer_load_dwordx4 v[188:191], v47, s[56:59], s81 offen offset:512 sc1
    buffer_load_dwordx4 v[192:195], v47, s[56:59], s82 offen sc1
    v_lshl_add_u32 v156, v29, 2, v156
    s_waitcnt lgkmcnt(4)
    v_mfma_f32_32x32x16_bf16 v[64:79], v[120:123], v[116:119], v[64:79]
    ds_read_b64_tr_b16 v[138:139], v24 offset:37888
    s_add_u32 m0, s41, 0
    s_add_u32 s15, s14, 28672
    buffer_load_dwordx4 v12, s[52:55], s14 offen offset:0 lds
    s_mul_i32 s26, s10, 544
    s_lshl_b32 s25, s11, 4
    s_waitcnt lgkmcnt(3)
    v_mfma_f32_32x32x16_bf16 v[80:95], v[124:127], v[112:115], v[80:95]
    ds_read_b128 v[132:135], v17 offset:36864
    ds_read_b64_tr_b16 v[140:141], v25 offset:36864
    s_add_u32 s25, s25, s26
    s_add_u32 s25, s25, 156432
    v_mfma_f32_32x32x16_bf16 v[96:111], v[124:127], v[116:119], v[96:111]
    ds_read_b64_tr_b16 v[142:143], v25 offset:37888
    buffer_load_dwordx4 v13, s[52:55], s14 offen offset:1024 lds
    v_lshl_add_u32 v46, v156, 5, s25
    s_mul_i32 s5, s10, 4352
    s_waitcnt lgkmcnt(3)
    v_mfma_f32_32x32x16_bf16 v[48:63], v[136:139], v[128:131], v[48:63]
    ds_read_b128 v[112:115], v18 offset:32768
    ds_read_b64_tr_b16 v[120:121], v24 offset:40960
    s_mul_i32 s27, s10, 4224
    s_add_u32 s5, s5, 147712
    s_waitcnt lgkmcnt(4)
    v_mfma_f32_32x32x16_bf16 v[64:79], v[136:139], v[132:135], v[64:79]
    ds_read_b64_tr_b16 v[122:123], v24 offset:41984
    buffer_load_dwordx4 v14, s[52:55], s14 offen offset:2048 lds
    s_add_u32 s27, s27, 139264
    s_cmp_eq_u32 s11, 0
    s_cselect_b32 s5, s5, s27
    s_waitcnt lgkmcnt(3)
    v_mfma_f32_32x32x16_bf16 v[80:95], v[140:143], v[128:131], v[80:95]
    ds_read_b128 v[116:119], v18 offset:36864
    ds_read_b64_tr_b16 v[124:125], v25 offset:40960
    v_lshl_add_u32 v158, v1, 2, s5
    s_mul_i32 s5, s10, 544
    v_mfma_f32_32x32x16_bf16 v[96:111], v[140:143], v[132:135], v[96:111]
    ds_read_b64_tr_b16 v[126:127], v25 offset:41984
    buffer_load_dwordx4 v15, s[52:55], s14 offen offset:3072 lds
    s_add_u32 s5, s5, 156416
    v_lshl_add_u32 v159, v30, 2, s5
    s_waitcnt lgkmcnt(3)
    v_mfma_f32_32x32x16_bf16 v[48:63], v[120:123], v[112:115], v[48:63]
    ds_read_b128 v[128:131], v19 offset:32768
    ds_read_b64_tr_b16 v[136:137], v24 offset:45056
    s_lshl_b32 s5, s11, 5
    v_and_b32 v160, s5, v1
    s_waitcnt lgkmcnt(4)
    v_mfma_f32_32x32x16_bf16 v[64:79], v[120:123], v[116:119], v[64:79]
    ds_read_b64_tr_b16 v[138:139], v24 offset:46080
    s_add_u32 m0, s41, 4096
    s_add_u32 s14, s14, 57344
    buffer_load_dwordx4 v12, s[52:55], s15 offen offset:0 lds
    s_cmp_eq_u32 s14, s101
    s_cselect_b32 s28, 401408, 0
    s_sub_u32 s14, s14, s28
    v_cmp_ne_u32 vcc, 0, v160
    s_nop 1
    v_cndmask_b32 v158, v158, v159, vcc
    ds_write_b32 v158, v31
    s_waitcnt lgkmcnt(4)
    v_mfma_f32_32x32x16_bf16 v[80:95], v[124:127], v[112:115], v[80:95]
    ds_read_b128 v[132:135], v19 offset:36864
    ds_read_b64_tr_b16 v[140:141], v25 offset:45056
    s_mul_i32 s5, s10, 4352
    s_lshl_b32 s27, s11, 11
    v_mfma_f32_32x32x16_bf16 v[96:111], v[124:127], v[116:119], v[96:111]
    ds_read_b64_tr_b16 v[142:143], v25 offset:46080
    buffer_load_dwordx4 v13, s[52:55], s15 offen offset:1024 lds
    s_add_u32 s5, s5, s27
    s_add_u32 s5, s5, 147968
    s_waitcnt lgkmcnt(4)
    v_mfma_f32_32x32x16_bf16 v[48:63], v[136:139], v[128:131], v[48:63]
    buffer_load_dwordx4 v14, s[52:55], s15 offen offset:2048 lds
    v_add_u32 v158, s5, v2
    ds_write_b128 v158, v[168:171]
    ds_write_b128 v158, v[172:175] offset:1024
    s_waitcnt lgkmcnt(4)
    v_mfma_f32_32x32x16_bf16 v[64:79], v[136:139], v[132:135], v[64:79]
    s_waitcnt vmcnt(21)
    s_waitcnt lgkmcnt(0)
    s_barrier
    ds_read_b128 v[112:115], v20 offset:0
    ds_read_b64_tr_b16 v[120:121], v26 offset:0
    ds_read_b64_tr_b16 v[122:123], v26 offset:1024
    v_mfma_f32_32x32x16_bf16 v[80:95], v[140:143], v[128:131], v[80:95]
    ds_read_b128 v[116:119], v20 offset:4096
    ds_read_b64_tr_b16 v[124:125], v27 offset:0
    ds_read_b64_tr_b16 v[126:127], v27 offset:1024
    v_mfma_f32_32x32x16_bf16 v[96:111], v[140:143], v[132:135], v[96:111]
    buffer_load_dwordx4 v15, s[52:55], s15 offen offset:3072 lds
    s_lshl_b32 s24, s10, 13
    s_lshl_b32 s25, s11, 12
    s_add_u32 s25, s25, s24
    s_waitcnt lgkmcnt(3)
    v_mfma_f32_32x32x16_bf16 v[48:63], v[120:123], v[112:115], v[48:63]
    ds_read_b128 v[128:131], v21 offset:0
    ds_read_b64_tr_b16 v[136:137], v26 offset:4096
    s_add_u32 s25, s25, 98304
    v_lshl_add_u32 v4, v1, 5, s25
    s_waitcnt lgkmcnt(4)
    v_mfma_f32_32x32x16_bf16 v[64:79], v[120:123], v[116:119], v[64:79]
    ds_read_b64_tr_b16 v[138:139], v26 offset:5120
    s_add_u32 m0, s41, 32768
    s_add_u32 s15, s14, 28672
    buffer_load_dwordx4 v12, s[52:55], s14 offen offset:0 lds
    v_lshrrev_b32 v6, 3, v1
    s_lshl_b32 s25, s11, 4
    s_waitcnt lgkmcnt(3)
    v_mfma_f32_32x32x16_bf16 v[80:95], v[124:127], v[112:115], v[80:95]
    ds_read_b128 v[132:135], v21 offset:4096
    ds_read_b64_tr_b16 v[140:141], v27 offset:4096
    v_add_u32 v6, s25, v6
    v_lshlrev_b32 v6, 4, v6
    v_mfma_f32_32x32x16_bf16 v[96:111], v[124:127], v[116:119], v[96:111]
    ds_read_b64_tr_b16 v[142:143], v27 offset:5120
    buffer_load_dwordx4 v13, s[52:55], s14 offen offset:1024 lds
    v_add_u32 v5, 128, v6
    v_and_b32 v156, 7, v1
    s_waitcnt lgkmcnt(3)
    v_mfma_f32_32x32x16_bf16 v[48:63], v[136:139], v[128:131], v[48:63]
    ds_read_b128 v[112:115], v22 offset:0
    ds_read_b64_tr_b16 v[120:121], v26 offset:8192
    v_cmp_eq_u32 vcc, 0, v156
    s_mul_i32 s26, s10, 544
    s_add_u32 s26, s26, 156416
    v_cndmask_b32 v6, 0, v6, vcc
    v_cndmask_b32 v5, 0, v5, vcc
    v_add_u32 v6, s26, v6
    s_waitcnt lgkmcnt(4)
    v_mfma_f32_32x32x16_bf16 v[64:79], v[136:139], v[132:135], v[64:79]
    ds_read_b64_tr_b16 v[122:123], v26 offset:9216
    buffer_load_dwordx4 v14, s[52:55], s14 offen offset:2048 lds
    v_add_u32 v5, s26, v5
    s_lshl_b32 s99, s11, 11
    s_waitcnt lgkmcnt(3)
    v_mfma_f32_32x32x16_bf16 v[80:95], v[140:143], v[128:131], v[80:95]
    ds_read_b128 v[116:119], v22 offset:4096
    ds_read_b64_tr_b16 v[124:125], v27 offset:8192
    s_add_u32 s99, s99, s96
    s_add_u32 s99, s99, 3145728
    v_mfma_f32_32x32x16_bf16 v[96:111], v[140:143], v[132:135], v[96:111]
    ds_read_b64_tr_b16 v[126:127], v27 offset:9216
    buffer_load_dwordx4 v15, s[52:55], s14 offen offset:3072 lds
    v_min_u32 v7, 6, v1
    v_lshlrev_b32 v7, 2, v7
    s_waitcnt vmcnt(17)
L_ckv:
    v_cmp_ne_u32 vcc, s32, v37
    s_cbranch_vccnz L_skv
L_rkv:
    s_mul_i32 s28, s10, 4224
    s_lshl_b32 s29, s11, 11
    s_add_u32 s28, s28, s29
    s_add_u32 m0, s28, 139392
    s_add_u32 s29, s29, s96
    s_add_u32 s29, s29, 1048576
    buffer_load_dwordx4 v2, s[56:59], s29 offen sc1 lds
    buffer_load_dwordx4 v2, s[56:59], s29 offen offset:1024 sc1 lds
    s_waitcnt lgkmcnt(3)
    v_mfma_f32_32x32x16_bf16 v[48:63], v[120:123], v[112:115], v[48:63]
    ds_read_b128 v[128:131], v23 offset:0
    ds_read_b64_tr_b16 v[136:137], v26 offset:12288
    s_lshl_b32 s24, s8, 1
    s_add_u32 s24, s24, s11
    s_waitcnt lgkmcnt(4)
    v_mfma_f32_32x32x16_bf16 v[64:79], v[120:123], v[116:119], v[64:79]
    ds_read_b64_tr_b16 v[138:139], v26 offset:13312
    s_add_u32 m0, s41, 36864
    s_add_u32 s14, s14, 57344
    buffer_load_dwordx4 v12, s[52:55], s15 offen offset:0 lds
    s_cmp_eq_u32 s14, s101
    s_cselect_b32 s28, 401408, 0
    s_sub_u32 s14, s14, s28
    s_xor_b32 s25, s24, 1
    s_mul_i32 s24, s24, 114688
    s_waitcnt lgkmcnt(3)
    v_mfma_f32_32x32x16_bf16 v[80:95], v[124:127], v[112:115], v[80:95]
    ds_read_b128 v[132:135], v23 offset:4096
    ds_read_b64_tr_b16 v[140:141], v27 offset:12288
    s_mul_i32 s25, s25, 114688
    s_mul_i32 s26, s3, 28672
    v_mfma_f32_32x32x16_bf16 v[96:111], v[124:127], v[116:119], v[96:111]
    ds_read_b64_tr_b16 v[142:143], v27 offset:13312
    buffer_load_dwordx4 v13, s[52:55], s15 offen offset:1024 lds
    s_add_u32 s26, s26, 5242880
    s_add_u32 s30, s24, s26
    s_waitcnt lgkmcnt(3)
    v_mfma_f32_32x32x16_bf16 v[48:63], v[136:139], v[128:131], v[48:63]
    buffer_load_dwordx4 v14, s[52:55], s15 offen offset:2048 lds
    s_add_u32 s31, s25, s26
    s_lshl_b32 s26, s100, 12
    s_add_u32 s12, s30, s26
    s_waitcnt lgkmcnt(2)
    v_mfma_f32_32x32x16_bf16 v[64:79], v[136:139], v[132:135], v[64:79]
    s_waitcnt lgkmcnt(0)
    v_mfma_f32_32x32x16_bf16 v[80:95], v[140:143], v[128:131], v[80:95]
    v_mfma_f32_32x32x16_bf16 v[96:111], v[140:143], v[132:135], v[96:111]
    buffer_load_dwordx4 v15, s[52:55], s15 offen offset:3072 lds
    s_add_u32 s13, s31, s26
    s_waitcnt vmcnt(18)
L_cgr:
    v_cmp_ne_u32 vcc, s32, v179
    v_cmp_ne_u32 s[38:39], s32, v183
    s_or_b64 vcc, vcc, s[38:39]
    v_cmp_ne_u32 s[38:39], s32, v187
    s_or_b64 vcc, vcc, s[38:39]
    v_cmp_ne_u32 s[38:39], s32, v191
    s_or_b64 vcc, vcc, s[38:39]
    v_cmp_ne_u32 s[38:39], s32, v195
    s_or_b64 vcc, vcc, s[38:39]
    s_cmp_lg_u64 vcc, 0
    s_cbranch_scc1 L_sgr
L_rgr:
    v_cndmask_b32 v176, 0, v176, s[36:37]
    v_cndmask_b32 v177, 0, v177, s[36:37]
    v_cndmask_b32 v180, 0, v180, s[36:37]
    v_cndmask_b32 v181, 0, v181, s[36:37]
    v_mov_b32 v179, 0
    v_mov_b32 v183, 0
    v_mov_b32 v187, 0
    v_mov_b32 v191, 0
    v_mov_b32 v34, v192
    v_mov_b32 v35, v193
    v_mfma_f32_32x32x16_bf16 v[48:63], v[184:187], v[176:179], v[48:63]
    v_mfma_f32_32x32x16_bf16 v[64:79], v[184:187], v[180:183], v[64:79]
    v_mfma_f32_32x32x16_bf16 v[80:95], v[188:191], v[176:179], v[80:95]
    v_mfma_f32_32x32x16_bf16 v[96:111], v[188:191], v[180:183], v[96:111]
    ds_read_b64_tr_b16 a[0:1], v40 offset:32768
    ds_read_b64_tr_b16 a[2:3], v40 offset:33792
    ds_read_b64_tr_b16 a[4:5], v41 offset:32768
    ds_read_b64_tr_b16 a[6:7], v41 offset:33792
    ds_read_b64_tr_b16 a[8:9], v40 offset:34816
    ds_read_b64_tr_b16 a[10:11], v40 offset:35840
    ds_read_b64_tr_b16 a[12:13], v41 offset:34816
    ds_read_b64_tr_b16 a[14:15], v41 offset:35840
    ds_read_b64_tr_b16 a[16:17], v40 offset:36864
    ds_read_b64_tr_b16 a[18:19], v40 offset:37888
    ds_read_b64_tr_b16 a[20:21], v41 offset:36864
    ds_read_b64_tr_b16 a[22:23], v41 offset:37888
    ds_read_b64_tr_b16 a[24:25], v40 offset:38912
    ds_read_b64_tr_b16 a[26:27], v40 offset:39936
    ds_read_b64_tr_b16 a[28:29], v41 offset:38912
    ds_read_b64_tr_b16 a[30:31], v41 offset:39936
    v_max_f32 v48, 0, v48
    v_max_f32 v49, 0, v49
    v_max_f32 v50, 0, v50
    v_max_f32 v51, 0, v51
    v_max_f32 v52, 0, v52
    v_max_f32 v53, 0, v53
    v_max_f32 v54, 0, v54
    v_max_f32 v55, 0, v55
    v_max_f32 v56, 0, v56
    v_max_f32 v57, 0, v57
    v_max_f32 v58, 0, v58
    v_max_f32 v59, 0, v59
    v_max_f32 v60, 0, v60
    v_max_f32 v61, 0, v61
    v_max_f32 v62, 0, v62
    v_max_f32 v63, 0, v63
    v_pk_mul_f32 v[48:49], v[48:49], v[48:49]
    v_pk_mul_f32 v[50:51], v[50:51], v[50:51]
    v_pk_mul_f32 v[52:53], v[52:53], v[52:53]
    v_pk_mul_f32 v[54:55], v[54:55], v[54:55]
    v_pk_mul_f32 v[56:57], v[56:57], v[56:57]
    v_pk_mul_f32 v[58:59], v[58:59], v[58:59]
    v_pk_mul_f32 v[60:61], v[60:61], v[60:61]
    v_pk_mul_f32 v[62:63], v[62:63], v[62:63]
    v_cvt_pk_bf16_f32 v48, v48, v49
    v_cvt_pk_bf16_f32 v49, v50, v51
    v_cvt_pk_bf16_f32 v50, v52, v53
    v_cvt_pk_bf16_f32 v51, v54, v55
    v_cvt_pk_bf16_f32 v52, v56, v57
    v_cvt_pk_bf16_f32 v53, v58, v59
    v_cvt_pk_bf16_f32 v54, v60, v61
    v_cvt_pk_bf16_f32 v55, v62, v63
    buffer_store_dwordx4 v[48:51], v2, s[56:59], s34 offen offset:0 sc1
    buffer_store_dwordx4 v[52:55], v2, s[56:59], s34 offen offset:1024 sc1
    v_max_f32 v64, 0, v64
    v_max_f32 v65, 0, v65
    v_max_f32 v66, 0, v66
    v_max_f32 v67, 0, v67
    v_max_f32 v68, 0, v68
    v_max_f32 v69, 0, v69
    v_max_f32 v70, 0, v70
    v_max_f32 v71, 0, v71
    v_max_f32 v72, 0, v72
    v_max_f32 v73, 0, v73
    v_max_f32 v74, 0, v74
    v_max_f32 v75, 0, v75
    v_max_f32 v76, 0, v76
    v_max_f32 v77, 0, v77
    v_max_f32 v78, 0, v78
    v_max_f32 v79, 0, v79
    v_pk_mul_f32 v[64:65], v[64:65], v[64:65]
    v_pk_mul_f32 v[66:67], v[66:67], v[66:67]
    v_pk_mul_f32 v[68:69], v[68:69], v[68:69]
    v_pk_mul_f32 v[70:71], v[70:71], v[70:71]
    v_pk_mul_f32 v[72:73], v[72:73], v[72:73]
    v_pk_mul_f32 v[74:75], v[74:75], v[74:75]
    v_pk_mul_f32 v[76:77], v[76:77], v[76:77]
    v_pk_mul_f32 v[78:79], v[78:79], v[78:79]
    v_cvt_pk_bf16_f32 v64, v64, v65
    v_cvt_pk_bf16_f32 v65, v66, v67
    v_cvt_pk_bf16_f32 v66, v68, v69
    v_cvt_pk_bf16_f32 v67, v70, v71
    v_cvt_pk_bf16_f32 v68, v72, v73
    v_cvt_pk_bf16_f32 v69, v74, v75
    v_cvt_pk_bf16_f32 v70, v76, v77
    v_cvt_pk_bf16_f32 v71, v78, v79
    buffer_store_dwordx4 v[64:67], v2, s[56:59], s35 offen offset:0 sc1
    buffer_store_dwordx4 v[68:71], v2, s[56:59], s35 offen offset:1024 sc1
    v_max_f32 v80, 0, v80
    v_max_f32 v81, 0, v81
    v_max_f32 v82, 0, v82
    v_max_f32 v83, 0, v83
    v_max_f32 v84, 0, v84
    v_max_f32 v85, 0, v85
    v_max_f32 v86, 0, v86
    v_max_f32 v87, 0, v87
    v_max_f32 v88, 0, v88
    v_max_f32 v89, 0, v89
    v_max_f32 v90, 0, v90
    v_max_f32 v91, 0, v91
    v_max_f32 v92, 0, v92
    v_max_f32 v93, 0, v93
    v_max_f32 v94, 0, v94
    v_max_f32 v95, 0, v95
    v_pk_mul_f32 v[80:81], v[80:81], v[80:81]
    v_pk_mul_f32 v[82:83], v[82:83], v[82:83]
    v_pk_mul_f32 v[84:85], v[84:85], v[84:85]
    v_pk_mul_f32 v[86:87], v[86:87], v[86:87]
    v_pk_mul_f32 v[88:89], v[88:89], v[88:89]
    v_pk_mul_f32 v[90:91], v[90:91], v[90:91]
    v_pk_mul_f32 v[92:93], v[92:93], v[92:93]
    v_pk_mul_f32 v[94:95], v[94:95], v[94:95]
    v_cvt_pk_bf16_f32 v80, v80, v81
    v_cvt_pk_bf16_f32 v81, v82, v83
    v_cvt_pk_bf16_f32 v82, v84, v85
    v_cvt_pk_bf16_f32 v83, v86, v87
    v_cvt_pk_bf16_f32 v84, v88, v89
    v_cvt_pk_bf16_f32 v85, v90, v91
    v_cvt_pk_bf16_f32 v86, v92, v93
    v_cvt_pk_bf16_f32 v87, v94, v95
    buffer_store_dwordx4 v[80:83], v2, s[56:59], s34 offen offset:2048 sc1
    buffer_store_dwordx4 v[84:87], v2, s[56:59], s34 offen offset:3072 sc1
    v_max_f32 v96, 0, v96
    v_max_f32 v97, 0, v97
    v_max_f32 v98, 0, v98
    v_max_f32 v99, 0, v99
    v_max_f32 v100, 0, v100
    v_max_f32 v101, 0, v101
    v_max_f32 v102, 0, v102
    v_max_f32 v103, 0, v103
    v_max_f32 v104, 0, v104
    v_max_f32 v105, 0, v105
    v_max_f32 v106, 0, v106
    v_max_f32 v107, 0, v107
    v_max_f32 v108, 0, v108
    v_max_f32 v109, 0, v109
    v_max_f32 v110, 0, v110
    v_max_f32 v111, 0, v111
    v_pk_mul_f32 v[96:97], v[96:97], v[96:97]
    v_pk_mul_f32 v[98:99], v[98:99], v[98:99]
    v_pk_mul_f32 v[100:101], v[100:101], v[100:101]
    v_pk_mul_f32 v[102:103], v[102:103], v[102:103]
    v_pk_mul_f32 v[104:105], v[104:105], v[104:105]
    v_pk_mul_f32 v[106:107], v[106:107], v[106:107]
    v_pk_mul_f32 v[108:109], v[108:109], v[108:109]
    v_pk_mul_f32 v[110:111], v[110:111], v[110:111]
    v_cvt_pk_bf16_f32 v96, v96, v97
    v_cvt_pk_bf16_f32 v97, v98, v99
    v_cvt_pk_bf16_f32 v98, v100, v101
    v_cvt_pk_bf16_f32 v99, v102, v103
    v_cvt_pk_bf16_f32 v100, v104, v105
    v_cvt_pk_bf16_f32 v101, v106, v107
    v_cvt_pk_bf16_f32 v102, v108, v109
    v_cvt_pk_bf16_f32 v103, v110, v111
    buffer_store_dwordx4 v[96:99], v2, s[56:59], s35 offen offset:2048 sc1
    buffer_store_dwordx4 v[100:103], v2, s[56:59], s35 offen offset:3072 sc1
    s_waitcnt vmcnt(12)
    s_waitcnt lgkmcnt(0)
    s_barrier
    ds_read_b64_tr_b16 v[240:241], v44 offset:32
    ds_read_b64_tr_b16 v[242:243], v44 offset:0
    ds_read2_b64 v[112:115], v42 offset0:0 offset1:4
    ds_read2_b64 v[116:119], v42 offset0:32 offset1:36
    ds_read2_b64 v[120:123], v42 offset0:64 offset1:68
    ds_read2_b64 v[124:127], v42 offset0:96 offset1:100
    ds_read_b64_tr_b16 v[244:245], v44 offset:288
    ds_read_b64_tr_b16 v[246:247], v44 offset:256
    ds_read2_b64 v[128:131], v42 offset0:128 offset1:132
    ds_read2_b64 v[132:135], v42 offset0:160 offset1:164
    ds_read2_b64 v[136:139], v42 offset0:192 offset1:196
    ds_read2_b64 v[140:143], v42 offset0:224 offset1:228
    ds_read2_b64 v[144:147], v43 offset0:0 offset1:4
    ds_read2_b64 v[148:151], v43 offset0:32 offset1:36
    ds_read2_b64 v[152:155], v43 offset0:64 offset1:68
    ds_read2_b64 v[156:159], v43 offset0:96 offset1:100
    ds_read2_b64 v[160:163], v43 offset0:128 offset1:132
    ds_read2_b64 v[164:167], v43 offset0:160 offset1:164
    ds_read2_b64 v[168:171], v43 offset0:192 offset1:196
    ds_read2_b64 v[172:175], v43 offset0:224 offset1:228
    s_waitcnt lgkmcnt(15)
    v_mfma_f32_16x16x32_bf16 v[176:179], v[112:115], v[240:243], 0
    v_mfma_f32_16x16x32_bf16 v[180:183], v[116:119], v[240:243], 0
    ds_read_b64_tr_b16 a[32:33], v38 offset:0
    v_mfma_f32_16x16x32_bf16 v[184:187], v[120:123], v[240:243], 0
    s_add_u32 m0, s41, 65536
    s_add_u32 s15, s14, 28672
    buffer_load_dwordx4 v12, s[52:55], s14 offen offset:0 lds
    s_waitcnt lgkmcnt(15)
    v_mfma_f32_16x16x32_bf16 v[188:191], v[124:127], v[240:243], 0
    ds_read_b64_tr_b16 a[34:35], v38 offset:1024
    s_waitcnt lgkmcnt(13)
    v_mfma_f32_16x16x32_bf16 v[192:195], v[128:131], v[240:243], 0
    ds_read_b64_tr_b16 a[36:37], v39 offset:0
    s_waitcnt lgkmcnt(13)
    v_mfma_f32_16x16x32_bf16 v[196:199], v[132:135], v[240:243], 0
    buffer_load_dwordx4 v13, s[52:55], s14 offen offset:1024 lds
    s_waitcnt lgkmcnt(12)
    v_mfma_f32_16x16x32_bf16 v[200:203], v[136:139], v[240:243], 0
    ds_read_b64_tr_b16 a[38:39], v39 offset:1024
    s_waitcnt lgkmcnt(12)
    v_mfma_f32_16x16x32_bf16 v[204:207], v[140:143], v[240:243], 0
    ds_read_b64_tr_b16 a[40:41], v38 offset:2048
    s_waitcnt lgkmcnt(12)
    v_mfma_f32_16x16x32_bf16 v[208:211], v[144:147], v[240:243], 0
    buffer_load_dwordx4 v14, s[52:55], s14 offen offset:2048 lds
    s_waitcnt lgkmcnt(11)
    v_mfma_f32_16x16x32_bf16 v[212:215], v[148:151], v[240:243], 0
    ds_read_b64_tr_b16 a[42:43], v38 offset:3072
    s_waitcnt lgkmcnt(11)
    v_mfma_f32_16x16x32_bf16 v[216:219], v[152:155], v[240:243], 0
    ds_read_b64_tr_b16 a[44:45], v39 offset:2048
    s_waitcnt lgkmcnt(11)
    v_mfma_f32_16x16x32_bf16 v[220:223], v[156:159], v[240:243], 0
    buffer_load_dwordx4 v15, s[52:55], s14 offen offset:3072 lds
    s_waitcnt lgkmcnt(10)
    v_mfma_f32_16x16x32_bf16 v[224:227], v[160:163], v[240:243], 0
    ds_read_b64_tr_b16 a[46:47], v39 offset:3072
    s_waitcnt lgkmcnt(10)
    v_mfma_f32_16x16x32_bf16 v[228:231], v[164:167], v[240:243], 0
    ds_read_b64_tr_b16 a[48:49], v38 offset:4096
    s_waitcnt lgkmcnt(10)
    v_mfma_f32_16x16x32_bf16 v[232:235], v[168:171], v[240:243], 0
    s_add_u32 m0, s41, 69632
    s_add_u32 s14, s14, 57344
    buffer_load_dwordx4 v12, s[52:55], s15 offen offset:0 lds
    s_cmp_eq_u32 s14, s101
    s_cselect_b32 s28, 401408, 0
    s_sub_u32 s14, s14, s28
    s_waitcnt lgkmcnt(9)
    v_mfma_f32_16x16x32_bf16 v[236:239], v[172:175], v[240:243], 0
    ds_read_b64_tr_b16 v[248:249], v44 offset:544
    ds_read_b64_tr_b16 v[250:251], v44 offset:512
    v_mfma_f32_16x16x32_bf16 v[180:183], v[112:115], v[244:247], v[180:183]
    ds_read_b64_tr_b16 v[240:241], v44 offset:800
    ds_read_b64_tr_b16 v[242:243], v44 offset:768
    v_mfma_f32_16x16x32_bf16 v[184:187], v[116:119], v[244:247], v[184:187]
    ds_read_b64_tr_b16 a[50:51], v38 offset:5120
    v_mfma_f32_16x16x32_bf16 v[188:191], v[120:123], v[244:247], v[188:191]
    ds_read_b64_tr_b16 a[52:53], v39 offset:4096
    v_mfma_f32_16x16x32_bf16 v[192:195], v[124:127], v[244:247], v[192:195]
    buffer_load_dwordx4 v13, s[52:55], s15 offen offset:1024 lds
    v_mfma_f32_16x16x32_bf16 v[196:199], v[128:131], v[244:247], v[196:199]
    ds_read_b64_tr_b16 a[54:55], v39 offset:5120
    v_mfma_f32_16x16x32_bf16 v[200:203], v[132:135], v[244:247], v[200:203]
    ds_read_b64_tr_b16 a[56:57], v38 offset:6144
    v_mfma_f32_16x16x32_bf16 v[204:207], v[136:139], v[244:247], v[204:207]
    buffer_load_dwordx4 v14, s[52:55], s15 offen offset:2048 lds
    v_mfma_f32_16x16x32_bf16 v[208:211], v[140:143], v[244:247], v[208:211]
    ds_read_b64_tr_b16 a[58:59], v38 offset:7168
    v_mfma_f32_16x16x32_bf16 v[212:215], v[144:147], v[244:247], v[212:215]
    ds_read_b64_tr_b16 a[60:61], v39 offset:6144
    v_mfma_f32_16x16x32_bf16 v[216:219], v[148:151], v[244:247], v[216:219]
    buffer_load_dwordx4 v15, s[52:55], s15 offen offset:3072 lds
    v_mfma_f32_16x16x32_bf16 v[220:223], v[152:155], v[244:247], v[220:223]
    ds_read_b64_tr_b16 a[62:63], v39 offset:7168
    v_mfma_f32_16x16x32_bf16 v[224:227], v[156:159], v[244:247], v[224:227]
    s_waitcnt vmcnt(8)
    buffer_store_dword v32, v31, s[56:59], s98 offen sc1
    v_mfma_f32_16x16x32_bf16 v[228:231], v[160:163], v[244:247], v[228:231]
    s_waitcnt lgkmcnt(0)
    v_mfma_f32_16x16x32_bf16 v[232:235], v[164:167], v[244:247], v[232:235]
    v_mfma_f32_16x16x32_bf16 v[236:239], v[168:171], v[244:247], v[236:239]
    ds_read_b64_tr_b16 a[64:65], v38 offset:32768
    v_mfma_f32_16x16x32_bf16 v[184:187], v[112:115], v[248:251], v[184:187]
    ds_read_b64_tr_b16 v[244:245], v44 offset:1056
    ds_read_b64_tr_b16 v[246:247], v44 offset:1024
    v_mfma_f32_16x16x32_bf16 v[188:191], v[116:119], v[248:251], v[188:191]
    s_add_u32 m0, s41, 0
    s_add_u32 s15, s14, 28672
    buffer_load_dwordx4 v12, s[52:55], s14 offen offset:0 lds
    v_mfma_f32_16x16x32_bf16 v[192:195], v[120:123], v[248:251], v[192:195]
    ds_read_b64_tr_b16 a[66:67], v38 offset:33792
    v_mfma_f32_16x16x32_bf16 v[196:199], v[124:127], v[248:251], v[196:199]
    ds_read_b64_tr_b16 a[68:69], v39 offset:32768
    v_mfma_f32_16x16x32_bf16 v[200:203], v[128:131], v[248:251], v[200:203]
    buffer_load_dwordx4 v13, s[52:55], s14 offen offset:1024 lds
    v_mfma_f32_16x16x32_bf16 v[204:207], v[132:135], v[248:251], v[204:207]
    ds_read_b64_tr_b16 a[70:71], v39 offset:33792
    v_mfma_f32_16x16x32_bf16 v[208:211], v[136:139], v[248:251], v[208:211]
    ds_read_b64_tr_b16 a[72:73], v38 offset:34816
    v_mfma_f32_16x16x32_bf16 v[212:215], v[140:143], v[248:251], v[212:215]
    buffer_load_dwordx4 v14, s[52:55], s14 offen offset:2048 lds
    v_mfma_f32_16x16x32_bf16 v[216:219], v[144:147], v[248:251], v[216:219]
    ds_read_b64_tr_b16 a[74:75], v38 offset:35840
    v_mfma_f32_16x16x32_bf16 v[220:223], v[148:151], v[248:251], v[220:223]
    ds_read_b64_tr_b16 a[76:77], v39 offset:34816
    v_mfma_f32_16x16x32_bf16 v[224:227], v[152:155], v[248:251], v[224:227]
    buffer_load_dwordx4 v15, s[52:55], s14 offen offset:3072 lds
    v_mfma_f32_16x16x32_bf16 v[228:231], v[156:159], v[248:251], v[228:231]
    ds_read_b64_tr_b16 a[78:79], v39 offset:35840
    v_mfma_f32_16x16x32_bf16 v[232:235], v[160:163], v[248:251], v[232:235]
    ds_read_b64_tr_b16 a[80:81], v38 offset:36864
    v_mfma_f32_16x16x32_bf16 v[236:239], v[164:167], v[248:251], v[236:239]
    s_add_u32 m0, s41, 4096
    s_add_u32 s14, s14, 57344
    buffer_load_dwordx4 v12, s[52:55], s15 offen offset:0 lds
    s_cmp_eq_u32 s14, s101
    s_cselect_b32 s28, 401408, 0
    s_sub_u32 s14, s14, s28
    v_mfma_f32_16x16x32_bf16 v[188:191], v[112:115], v[240:243], v[188:191]
    ds_read_b64_tr_b16 v[248:249], v44 offset:1312
    ds_read_b64_tr_b16 v[250:251], v44 offset:1280
    v_mfma_f32_16x16x32_bf16 v[192:195], v[116:119], v[240:243], v[192:195]
    ds_read_b64_tr_b16 a[82:83], v38 offset:37888
    v_mfma_f32_16x16x32_bf16 v[196:199], v[120:123], v[240:243], v[196:199]
    ds_read_b64_tr_b16 a[84:85], v39 offset:36864
    v_mfma_f32_16x16x32_bf16 v[200:203], v[124:127], v[240:243], v[200:203]
    buffer_load_dwordx4 v13, s[52:55], s15 offen offset:1024 lds
    v_mfma_f32_16x16x32_bf16 v[204:207], v[128:131], v[240:243], v[204:207]
    ds_read_b64_tr_b16 a[86:87], v39 offset:37888
    v_mfma_f32_16x16x32_bf16 v[208:211], v[132:135], v[240:243], v[208:211]
    ds_read_b64_tr_b16 a[88:89], v38 offset:38912
    v_mfma_f32_16x16x32_bf16 v[212:215], v[136:139], v[240:243], v[212:215]
    buffer_load_dwordx4 v14, s[52:55], s15 offen offset:2048 lds
    v_mfma_f32_16x16x32_bf16 v[216:219], v[140:143], v[240:243], v[216:219]
    ds_read_b64_tr_b16 a[90:91], v38 offset:39936
    v_mfma_f32_16x16x32_bf16 v[220:223], v[144:147], v[240:243], v[220:223]
    ds_read_b64_tr_b16 a[92:93], v39 offset:38912
    v_mfma_f32_16x16x32_bf16 v[224:227], v[148:151], v[240:243], v[224:227]
    buffer_load_dwordx4 v15, s[52:55], s15 offen offset:3072 lds
    v_mfma_f32_16x16x32_bf16 v[228:231], v[152:155], v[240:243], v[228:231]
    ds_read_b64_tr_b16 a[94:95], v39 offset:39936
    v_mfma_f32_16x16x32_bf16 v[232:235], v[156:159], v[240:243], v[232:235]
    s_waitcnt lgkmcnt(0)
    v_mfma_f32_16x16x32_bf16 v[236:239], v[160:163], v[240:243], v[236:239]
    s_add_u32 m0, s41, 32768
    s_add_u32 s15, s14, 28672
    buffer_load_dwordx4 v12, s[52:55], s14 offen offset:0 lds
    v_mfma_f32_16x16x32_bf16 v[192:195], v[112:115], v[244:247], v[192:195]
    ds_read_b64_tr_b16 v[240:241], v44 offset:1568
    ds_read_b64_tr_b16 v[242:243], v44 offset:1536
    v_mfma_f32_16x16x32_bf16 v[196:199], v[116:119], v[244:247], v[196:199]
    buffer_load_dwordx4 v13, s[52:55], s14 offen offset:1024 lds
    v_mfma_f32_16x16x32_bf16 v[200:203], v[120:123], v[244:247], v[200:203]
    buffer_load_dwordx4 v14, s[52:55], s14 offen offset:2048 lds
    v_mfma_f32_16x16x32_bf16 v[204:207], v[124:127], v[244:247], v[204:207]
    buffer_load_dwordx4 v15, s[52:55], s14 offen offset:3072 lds
    v_mfma_f32_16x16x32_bf16 v[208:211], v[128:131], v[244:247], v[208:211]
    s_add_u32 m0, s41, 36864
    s_add_u32 s14, s14, 57344
    buffer_load_dwordx4 v12, s[52:55], s15 offen offset:0 lds
    s_cmp_eq_u32 s14, s101
    s_cselect_b32 s28, 401408, 0
    s_sub_u32 s14, s14, s28
    v_mfma_f32_16x16x32_bf16 v[212:215], v[132:135], v[244:247], v[212:215]
    buffer_load_dwordx4 v13, s[52:55], s15 offen offset:1024 lds
    v_mfma_f32_16x16x32_bf16 v[216:219], v[136:139], v[244:247], v[216:219]
    buffer_load_dwordx4 v14, s[52:55], s15 offen offset:2048 lds
    v_mfma_f32_16x16x32_bf16 v[220:223], v[140:143], v[244:247], v[220:223]
    buffer_load_dwordx4 v15, s[52:55], s15 offen offset:3072 lds
    v_mfma_f32_16x16x32_bf16 v[224:227], v[144:147], v[244:247], v[224:227]
    s_waitcnt vmcnt(17)
    v_mfma_f32_16x16x32_bf16 v[228:231], v[148:151], v[244:247], v[228:231]
    ds_read_b64_tr_b16 a[96:97], v40 offset:0
    v_mfma_f32_16x16x32_bf16 v[232:235], v[152:155], v[244:247], v[232:235]
    ds_read_b64_tr_b16 a[98:99], v40 offset:1024
    v_mfma_f32_16x16x32_bf16 v[236:239], v[156:159], v[244:247], v[236:239]
    ds_read_b64_tr_b16 a[100:101], v41 offset:0
    v_mfma_f32_16x16x32_bf16 v[196:199], v[112:115], v[248:251], v[196:199]
    ds_read_b64_tr_b16 v[244:245], v44 offset:1824
    ds_read_b64_tr_b16 v[246:247], v44 offset:1792
    v_mfma_f32_16x16x32_bf16 v[200:203], v[116:119], v[248:251], v[200:203]
    ds_read_b64_tr_b16 a[102:103], v41 offset:1024
    v_mfma_f32_16x16x32_bf16 v[204:207], v[120:123], v[248:251], v[204:207]
    ds_read_b64_tr_b16 a[104:105], v40 offset:2048
    v_mfma_f32_16x16x32_bf16 v[208:211], v[124:127], v[248:251], v[208:211]
    ds_read_b64_tr_b16 a[106:107], v40 offset:3072
    v_mfma_f32_16x16x32_bf16 v[212:215], v[128:131], v[248:251], v[212:215]
    ds_read_b64_tr_b16 a[108:109], v41 offset:2048
    v_mfma_f32_16x16x32_bf16 v[216:219], v[132:135], v[248:251], v[216:219]
    ds_read_b64_tr_b16 a[110:111], v41 offset:3072
    v_mfma_f32_16x16x32_bf16 v[220:223], v[136:139], v[248:251], v[220:223]
    ds_read_b64_tr_b16 a[112:113], v40 offset:4096
    v_mfma_f32_16x16x32_bf16 v[224:227], v[140:143], v[248:251], v[224:227]
    ds_read_b64_tr_b16 a[114:115], v40 offset:5120
    v_mfma_f32_16x16x32_bf16 v[228:231], v[144:147], v[248:251], v[228:231]
    ds_read_b64_tr_b16 a[116:117], v41 offset:4096
    v_mfma_f32_16x16x32_bf16 v[232:235], v[148:151], v[248:251], v[232:235]
    ds_read_b64_tr_b16 a[118:119], v41 offset:5120
    v_mfma_f32_16x16x32_bf16 v[236:239], v[152:155], v[248:251], v[236:239]
    ds_read_b64_tr_b16 a[120:121], v40 offset:6144
    s_waitcnt lgkmcnt(15)
    v_mfma_f32_16x16x32_bf16 v[200:203], v[112:115], v[240:243], v[200:203]
    ds_read_b64_tr_b16 v[248:249], v44 offset:2080
    ds_read_b64_tr_b16 v[250:251], v44 offset:2048
    v_mfma_f32_16x16x32_bf16 v[204:207], v[116:119], v[240:243], v[204:207]
    ds_read_b64_tr_b16 a[122:123], v40 offset:7168
    v_mfma_f32_16x16x32_bf16 v[208:211], v[120:123], v[240:243], v[208:211]
    ds_read_b64_tr_b16 a[124:125], v41 offset:6144
    v_mfma_f32_16x16x32_bf16 v[212:215], v[124:127], v[240:243], v[212:215]
    ds_read_b64_tr_b16 a[126:127], v41 offset:7168
    v_mfma_f32_16x16x32_bf16 v[216:219], v[128:131], v[240:243], v[216:219]
    buffer_load_dword v8, v7, s[56:59], s97 offen sc1
    v_mfma_f32_16x16x32_bf16 v[220:223], v[132:135], v[240:243], v[220:223]
    s_waitcnt lgkmcnt(0)
    v_mfma_f32_16x16x32_bf16 v[224:227], v[136:139], v[240:243], v[224:227]
    s_add_u32 m0, s41, 65536
    s_add_u32 s15, s14, 28672
    buffer_load_dwordx4 v12, s[52:55], s14 offen offset:0 lds
    v_mfma_f32_16x16x32_bf16 v[228:231], v[140:143], v[240:243], v[228:231]
    buffer_load_dwordx4 v13, s[52:55], s14 offen offset:1024 lds
    v_mfma_f32_16x16x32_bf16 v[232:235], v[144:147], v[240:243], v[232:235]
    buffer_load_dwordx4 v14, s[52:55], s14 offen offset:2048 lds
    v_mfma_f32_16x16x32_bf16 v[236:239], v[148:151], v[240:243], v[236:239]
    buffer_load_dwordx4 v15, s[52:55], s14 offen offset:3072 lds
    v_mfma_f32_16x16x32_bf16 v[204:207], v[112:115], v[244:247], v[204:207]
    ds_read_b64_tr_b16 v[240:241], v44 offset:2336
    ds_read_b64_tr_b16 v[242:243], v44 offset:2304
    v_mfma_f32_16x16x32_bf16 v[208:211], v[116:119], v[244:247], v[208:211]
    s_add_u32 m0, s41, 69632
    s_add_u32 s14, s14, 57344
    buffer_load_dwordx4 v12, s[52:55], s15 offen offset:0 lds
    s_cmp_eq_u32 s14, s101
    s_cselect_b32 s28, 401408, 0
    s_sub_u32 s14, s14, s28
    v_mfma_f32_16x16x32_bf16 v[212:215], v[120:123], v[244:247], v[212:215]
    buffer_load_dwordx4 v13, s[52:55], s15 offen offset:1024 lds
    v_mfma_f32_16x16x32_bf16 v[216:219], v[124:127], v[244:247], v[216:219]
    buffer_load_dwordx4 v14, s[52:55], s15 offen offset:2048 lds
    v_mfma_f32_16x16x32_bf16 v[220:223], v[128:131], v[244:247], v[220:223]
    buffer_load_dwordx4 v15, s[52:55], s15 offen offset:3072 lds
    v_mfma_f32_16x16x32_bf16 v[224:227], v[132:135], v[244:247], v[224:227]
    s_waitcnt vmcnt(17)
    v_mfma_f32_16x16x32_bf16 v[228:231], v[136:139], v[244:247], v[228:231]
    ds_read_b64_tr_b16 a[128:129], v38 offset:0
    v_mfma_f32_16x16x32_bf16 v[232:235], v[140:143], v[244:247], v[232:235]
    ds_read_b64_tr_b16 a[130:131], v38 offset:1024
    v_mfma_f32_16x16x32_bf16 v[236:239], v[144:147], v[244:247], v[236:239]
    ds_read_b64_tr_b16 a[132:133], v39 offset:0
    v_mfma_f32_16x16x32_bf16 v[208:211], v[112:115], v[248:251], v[208:211]
    ds_read_b64_tr_b16 v[244:245], v44 offset:2592
    ds_read_b64_tr_b16 v[246:247], v44 offset:2560
    v_mfma_f32_16x16x32_bf16 v[212:215], v[116:119], v[248:251], v[212:215]
    ds_read_b64_tr_b16 a[134:135], v39 offset:1024
    v_mfma_f32_16x16x32_bf16 v[216:219], v[120:123], v[248:251], v[216:219]
    ds_read_b64_tr_b16 a[136:137], v38 offset:2048
    v_mfma_f32_16x16x32_bf16 v[220:223], v[124:127], v[248:251], v[220:223]
    ds_read_b64_tr_b16 a[138:139], v38 offset:3072
    v_mfma_f32_16x16x32_bf16 v[224:227], v[128:131], v[248:251], v[224:227]
    ds_read_b64_tr_b16 a[140:141], v39 offset:2048
    v_mfma_f32_16x16x32_bf16 v[228:231], v[132:135], v[248:251], v[228:231]
    ds_read_b64_tr_b16 a[142:143], v39 offset:3072
    v_mfma_f32_16x16x32_bf16 v[232:235], v[136:139], v[248:251], v[232:235]
    ds_read_b64_tr_b16 a[144:145], v38 offset:4096
    v_mfma_f32_16x16x32_bf16 v[236:239], v[140:143], v[248:251], v[236:239]
    ds_read_b64_tr_b16 a[146:147], v38 offset:5120
    s_waitcnt lgkmcnt(12)
    v_mfma_f32_16x16x32_bf16 v[212:215], v[112:115], v[240:243], v[212:215]
    ds_read_b64_tr_b16 v[248:249], v44 offset:2848
    ds_read_b64_tr_b16 v[250:251], v44 offset:2816
    v_mfma_f32_16x16x32_bf16 v[216:219], v[116:119], v[240:243], v[216:219]
    ds_read_b64_tr_b16 a[148:149], v39 offset:4096
    v_mfma_f32_16x16x32_bf16 v[220:223], v[120:123], v[240:243], v[220:223]
    ds_read_b64_tr_b16 a[150:151], v39 offset:5120
    v_mfma_f32_16x16x32_bf16 v[224:227], v[124:127], v[240:243], v[224:227]
    ds_read_b64_tr_b16 a[152:153], v38 offset:6144
    v_mfma_f32_16x16x32_bf16 v[228:231], v[128:131], v[240:243], v[228:231]
    ds_read_b64_tr_b16 a[154:155], v38 offset:7168
    v_mfma_f32_16x16x32_bf16 v[232:235], v[132:135], v[240:243], v[232:235]
    ds_read_b64_tr_b16 a[156:157], v39 offset:6144
    v_mfma_f32_16x16x32_bf16 v[236:239], v[136:139], v[240:243], v[236:239]
    ds_read_b64_tr_b16 a[158:159], v39 offset:7168
    s_waitcnt lgkmcnt(15)
    v_mfma_f32_16x16x32_bf16 v[216:219], v[112:115], v[244:247], v[216:219]
    ds_read_b64_tr_b16 v[240:241], v44 offset:3104
    ds_read_b64_tr_b16 v[242:243], v44 offset:3072
    v_mfma_f32_16x16x32_bf16 v[220:223], v[116:119], v[244:247], v[220:223]
    s_waitcnt vmcnt(8)
L_chf:
    v_cmp_ne_u32 vcc, s32, v8
    s_cbranch_vccnz L_shf
L_rhf:
    v_mfma_f32_16x16x32_bf16 v[224:227], v[120:123], v[244:247], v[224:227]
    buffer_load_dwordx4 a[224:227], v2, s[56:59], s12 offen offset:0 sc1
    v_mfma_f32_16x16x32_bf16 v[228:231], v[124:127], v[244:247], v[228:231]
    buffer_load_dwordx4 a[228:231], v2, s[56:59], s13 offen offset:0 sc1
    v_mfma_f32_16x16x32_bf16 v[232:235], v[128:131], v[244:247], v[232:235]
    buffer_load_dwordx4 a[232:235], v2, s[56:59], s12 offen offset:1024 sc1
    v_mfma_f32_16x16x32_bf16 v[236:239], v[132:135], v[244:247], v[236:239]
    buffer_load_dwordx4 a[236:239], v2, s[56:59], s13 offen offset:1024 sc1
    s_waitcnt lgkmcnt(8)
    v_mfma_f32_16x16x32_bf16 v[220:223], v[112:115], v[248:251], v[220:223]
    ds_read_b64_tr_b16 v[244:245], v44 offset:3360
    ds_read_b64_tr_b16 v[246:247], v44 offset:3328
    v_mfma_f32_16x16x32_bf16 v[224:227], v[116:119], v[248:251], v[224:227]
    buffer_load_dwordx4 a[240:243], v2, s[56:59], s12 offen offset:2048 sc1
    v_mfma_f32_16x16x32_bf16 v[228:231], v[120:123], v[248:251], v[228:231]
    buffer_load_dwordx4 a[244:247], v2, s[56:59], s13 offen offset:2048 sc1
    v_mfma_f32_16x16x32_bf16 v[232:235], v[124:127], v[248:251], v[232:235]
    buffer_load_dwordx4 a[248:251], v2, s[56:59], s12 offen offset:3072 sc1
    v_mfma_f32_16x16x32_bf16 v[236:239], v[128:131], v[248:251], v[236:239]
    buffer_load_dwordx4 a[252:255], v2, s[56:59], s13 offen offset:3072 sc1
    s_waitcnt lgkmcnt(2)
    v_mfma_f32_16x16x32_bf16 v[224:227], v[112:115], v[240:243], v[224:227]
    ds_read_b64_tr_b16 v[248:249], v44 offset:3616
    ds_read_b64_tr_b16 v[250:251], v44 offset:3584
    v_mfma_f32_16x16x32_bf16 v[228:231], v[116:119], v[240:243], v[228:231]
    s_add_u32 s100, s100, 1
    s_add_u32 s12, s12, 4096
    s_add_u32 s13, s13, 4096
    s_cmp_eq_u32 s100, 7
    s_cselect_b32 s12, s30, s12
    s_cselect_b32 s13, s31, s13
    buffer_load_dwordx4 v[48:51], v2, s[56:59], s12 offen offset:0 sc1
    v_mfma_f32_16x16x32_bf16 v[232:235], v[120:123], v[240:243], v[232:235]
    buffer_load_dwordx4 v[52:55], v2, s[56:59], s13 offen offset:0 sc1
    v_mfma_f32_16x16x32_bf16 v[236:239], v[124:127], v[240:243], v[236:239]
    buffer_load_dwordx4 v[56:59], v2, s[56:59], s12 offen offset:1024 sc1
    s_waitcnt lgkmcnt(2)
    v_mfma_f32_16x16x32_bf16 v[228:231], v[112:115], v[244:247], v[228:231]
    ds_read_b64_tr_b16 v[240:241], v44 offset:3872
    ds_read_b64_tr_b16 v[242:243], v44 offset:3840
    v_mfma_f32_16x16x32_bf16 v[232:235], v[116:119], v[244:247], v[232:235]
    buffer_load_dwordx4 v[60:63], v2, s[56:59], s13 offen offset:1024 sc1
    v_mfma_f32_16x16x32_bf16 v[236:239], v[120:123], v[244:247], v[236:239]
    buffer_load_dwordx4 v[64:67], v2, s[56:59], s12 offen offset:2048 sc1
    s_waitcnt lgkmcnt(2)
    v_mfma_f32_16x16x32_bf16 v[232:235], v[112:115], v[248:251], v[232:235]
    buffer_load_dwordx4 v[68:71], v2, s[56:59], s13 offen offset:2048 sc1
    v_mfma_f32_16x16x32_bf16 v[236:239], v[116:119], v[248:251], v[236:239]
    buffer_load_dwordx4 v[72:75], v2, s[56:59], s12 offen offset:3072 sc1
    s_waitcnt lgkmcnt(0)
    v_mfma_f32_16x16x32_bf16 v[236:239], v[112:115], v[240:243], v[236:239]
    buffer_load_dwordx4 v[76:79], v2, s[56:59], s13 offen offset:3072 sc1
    s_nop 7
    v_add_f32_dpp v178, v179, v178 wave_shr:1 row_mask:0xf bank_mask:0xf bound_ctrl:0
    v_add_f32_dpp v182, v183, v182 wave_shr:1 row_mask:0xf bank_mask:0xf bound_ctrl:0
    v_add_f32_dpp v186, v187, v186 wave_shr:1 row_mask:0xf bank_mask:0xf bound_ctrl:0
    v_add_f32_dpp v190, v191, v190 wave_shr:1 row_mask:0xf bank_mask:0xf bound_ctrl:0
    s_add_u32 s100, s100, 1
    s_add_u32 s12, s12, 4096
    s_add_u32 s13, s13, 4096
    s_cmp_eq_u32 s100, 7
    s_cselect_b32 s12, s30, s12
    s_cselect_b32 s13, s31, s13
    buffer_load_dwordx4 v[80:83], v2, s[56:59], s12 offen offset:0 sc1
    v_add_f32_dpp v194, v195, v194 wave_shr:1 row_mask:0xf bank_mask:0xf bound_ctrl:0
    v_add_f32_dpp v198, v199, v198 wave_shr:1 row_mask:0xf bank_mask:0xf bound_ctrl:0
    v_add_f32_dpp v202, v203, v202 wave_shr:1 row_mask:0xf bank_mask:0xf bound_ctrl:0
    v_add_f32_dpp v206, v207, v206 wave_shr:1 row_mask:0xf bank_mask:0xf bound_ctrl:0
    buffer_load_dwordx4 v[84:87], v2, s[56:59], s13 offen offset:0 sc1
    v_add_f32_dpp v210, v211, v210 wave_shr:1 row_mask:0xf bank_mask:0xf bound_ctrl:0
    v_add_f32_dpp v214, v215, v214 wave_shr:1 row_mask:0xf bank_mask:0xf bound_ctrl:0
    v_add_f32_dpp v218, v219, v218 wave_shr:1 row_mask:0xf bank_mask:0xf bound_ctrl:0
    v_add_f32_dpp v222, v223, v222 wave_shr:1 row_mask:0xf bank_mask:0xf bound_ctrl:0
    buffer_load_dwordx4 v[88:91], v2, s[56:59], s12 offen offset:1024 sc1
    v_add_f32_dpp v226, v227, v226 wave_shr:1 row_mask:0xf bank_mask:0xf bound_ctrl:0
    v_add_f32_dpp v230, v231, v230 wave_shr:1 row_mask:0xf bank_mask:0xf bound_ctrl:0
    v_add_f32_dpp v234, v235, v234 wave_shr:1 row_mask:0xf bank_mask:0xf bound_ctrl:0
    v_add_f32_dpp v238, v239, v238 wave_shr:1 row_mask:0xf bank_mask:0xf bound_ctrl:0
    buffer_load_dwordx4 v[92:95], v2, s[56:59], s13 offen offset:1024 sc1
    v_add_f32_dpp v177, v178, v177 wave_shr:1 row_mask:0xf bank_mask:0xf bound_ctrl:0
    v_add_f32_dpp v181, v182, v181 wave_shr:1 row_mask:0xf bank_mask:0xf bound_ctrl:0
    v_add_f32_dpp v185, v186, v185 wave_shr:1 row_mask:0xf bank_mask:0xf bound_ctrl:0
    v_add_f32_dpp v189, v190, v189 wave_shr:1 row_mask:0xf bank_mask:0xf bound_ctrl:0
    buffer_load_dwordx4 v[96:99], v2, s[56:59], s12 offen offset:2048 sc1
    v_add_f32_dpp v193, v194, v193 wave_shr:1 row_mask:0xf bank_mask:0xf bound_ctrl:0
    v_add_f32_dpp v197, v198, v197 wave_shr:1 row_mask:0xf bank_mask:0xf bound_ctrl:0
    v_add_f32_dpp v201, v202, v201 wave_shr:1 row_mask:0xf bank_mask:0xf bound_ctrl:0
    v_add_f32_dpp v205, v206, v205 wave_shr:1 row_mask:0xf bank_mask:0xf bound_ctrl:0
    buffer_load_dwordx4 v[100:103], v2, s[56:59], s13 offen offset:2048 sc1
    v_add_f32_dpp v209, v210, v209 wave_shr:1 row_mask:0xf bank_mask:0xf bound_ctrl:0
    v_add_f32_dpp v213, v214, v213 wave_shr:1 row_mask:0xf bank_mask:0xf bound_ctrl:0
    v_add_f32_dpp v217, v218, v217 wave_shr:1 row_mask:0xf bank_mask:0xf bound_ctrl:0
    v_add_f32_dpp v221, v222, v221 wave_shr:1 row_mask:0xf bank_mask:0xf bound_ctrl:0
    buffer_load_dwordx4 v[104:107], v2, s[56:59], s12 offen offset:3072 sc1
    v_add_f32_dpp v225, v226, v225 wave_shr:1 row_mask:0xf bank_mask:0xf bound_ctrl:0
    v_add_f32_dpp v229, v230, v229 wave_shr:1 row_mask:0xf bank_mask:0xf bound_ctrl:0
    v_add_f32_dpp v233, v234, v233 wave_shr:1 row_mask:0xf bank_mask:0xf bound_ctrl:0
    v_add_f32_dpp v237, v238, v237 wave_shr:1 row_mask:0xf bank_mask:0xf bound_ctrl:0
    buffer_load_dwordx4 v[108:111], v2, s[56:59], s13 offen offset:3072 sc1
    v_add_f32_dpp v176, v177, v176 wave_shr:1 row_mask:0xf bank_mask:0xf bound_ctrl:0
    v_add_f32_dpp v180, v181, v180 wave_shr:1 row_mask:0xf bank_mask:0xf bound_ctrl:0
    v_add_f32_dpp v184, v185, v184 wave_shr:1 row_mask:0xf bank_mask:0xf bound_ctrl:0
    v_add_f32_dpp v188, v189, v188 wave_shr:1 row_mask:0xf bank_mask:0xf bound_ctrl:0
    v_add_f32_dpp v192, v193, v192 wave_shr:1 row_mask:0xf bank_mask:0xf bound_ctrl:0
    v_add_f32_dpp v196, v197, v196 wave_shr:1 row_mask:0xf bank_mask:0xf bound_ctrl:0
    v_add_f32_dpp v200, v201, v200 wave_shr:1 row_mask:0xf bank_mask:0xf bound_ctrl:0
    v_add_f32_dpp v204, v205, v204 wave_shr:1 row_mask:0xf bank_mask:0xf bound_ctrl:0
    v_add_f32_dpp v208, v209, v208 wave_shr:1 row_mask:0xf bank_mask:0xf bound_ctrl:0
    v_add_f32_dpp v212, v213, v212 wave_shr:1 row_mask:0xf bank_mask:0xf bound_ctrl:0
    v_add_f32_dpp v216, v217, v216 wave_shr:1 row_mask:0xf bank_mask:0xf bound_ctrl:0
    v_add_f32_dpp v220, v221, v220 wave_shr:1 row_mask:0xf bank_mask:0xf bound_ctrl:0
    v_add_f32_dpp v224, v225, v224 wave_shr:1 row_mask:0xf bank_mask:0xf bound_ctrl:0
    v_add_f32_dpp v228, v229, v228 wave_shr:1 row_mask:0xf bank_mask:0xf bound_ctrl:0
    v_add_f32_dpp v232, v233, v232 wave_shr:1 row_mask:0xf bank_mask:0xf bound_ctrl:0
    v_add_f32_dpp v236, v237, v236 wave_shr:1 row_mask:0xf bank_mask:0xf bound_ctrl:0
    ds_write_b32 v45, v176 offset:0
    v_permlane32_swap_b32 v177, v181
    v_permlane32_swap_b32 v178, v182
    v_permlane32_swap_b32 v179, v183
    ds_write_b32 v45, v180 offset:512
    v_permlane32_swap_b32 v185, v189
    v_permlane32_swap_b32 v186, v190
    v_permlane32_swap_b32 v187, v191
    ds_write_b32 v45, v184 offset:1024
    v_permlane32_swap_b32 v193, v197
    v_permlane32_swap_b32 v194, v198
    v_permlane32_swap_b32 v195, v199
    ds_write_b32 v45, v188 offset:1536
    v_permlane32_swap_b32 v201, v205
    v_permlane32_swap_b32 v202, v206
    v_permlane32_swap_b32 v203, v207
    ds_write_b32 v45, v192 offset:2048
    v_permlane32_swap_b32 v209, v213
    v_permlane32_swap_b32 v210, v214
    v_permlane32_swap_b32 v211, v215
    ds_write_b32 v45, v196 offset:2560
    v_permlane32_swap_b32 v217, v221
    v_permlane32_swap_b32 v218, v222
    v_permlane32_swap_b32 v219, v223
    ds_write_b32 v45, v200 offset:3072
    v_permlane32_swap_b32 v225, v229
    v_permlane32_swap_b32 v226, v230
    v_permlane32_swap_b32 v227, v231
    ds_write_b32 v45, v204 offset:3584
    v_permlane32_swap_b32 v233, v237
    v_permlane32_swap_b32 v234, v238
    v_permlane32_swap_b32 v235, v239
    ds_write_b32 v45, v208 offset:4096
    v_permlane16_swap_b32 v181, v189
    v_permlane16_swap_b32 v182, v190
    v_permlane16_swap_b32 v183, v191
    ds_write_b32 v45, v212 offset:4608
    v_permlane16_swap_b32 v197, v205
    v_permlane16_swap_b32 v198, v206
    v_permlane16_swap_b32 v199, v207
    ds_write_b32 v45, v216 offset:5120
    v_permlane16_swap_b32 v213, v221
    v_permlane16_swap_b32 v214, v222
    v_permlane16_swap_b32 v215, v223
    ds_write_b32 v45, v220 offset:5632
    v_permlane16_swap_b32 v229, v237
    v_permlane16_swap_b32 v230, v238
    v_permlane16_swap_b32 v231, v239
    ds_write_b32 v45, v224 offset:6144
    v_mov_b32_dpp v237, v189 row_shl:12 row_mask:0xf bank_mask:0x1
    v_mov_b32_dpp v238, v190 row_shl:12 row_mask:0xf bank_mask:0x1
    v_mov_b32_dpp v239, v191 row_shl:12 row_mask:0xf bank_mask:0x1
    ds_write_b32 v45, v228 offset:6656
    v_mov_b32_dpp v237, v205 row_shl:8 row_mask:0xf bank_mask:0x2
    v_mov_b32_dpp v238, v206 row_shl:8 row_mask:0xf bank_mask:0x2
    v_mov_b32_dpp v239, v207 row_shl:8 row_mask:0xf bank_mask:0x2
    ds_write_b32 v45, v232 offset:7168
    v_mov_b32_dpp v237, v221 row_shl:4 row_mask:0xf bank_mask:0x4
    v_mov_b32_dpp v238, v222 row_shl:4 row_mask:0xf bank_mask:0x4
    v_mov_b32_dpp v239, v223 row_shl:4 row_mask:0xf bank_mask:0x4
    ds_write_b32 v45, v236 offset:7680
    s_mov_b32 exec_lo, 0x88888888
    s_mov_b32 exec_hi, 0x88888888
    ds_write_b128 v46, v[236:239]
    s_mov_b64 exec, -1
    s_waitcnt lgkmcnt(0)
    s_barrier
    ds_read_b128 v[176:179], v4 offset:0
    ds_read_b128 v[180:183], v4 offset:16
    ds_read_b128 v[192:195], v6
    ds_read_b128 v[184:187], v4 offset:2048
    ds_read_b128 v[188:191], v4 offset:2064
    ds_read_b128 v[196:199], v5
    s_waitcnt lgkmcnt(3)
    v_add_f32 v176, v176, v193
    v_add_f32 v177, v177, v194
    v_add_f32 v178, v178, v195
    v_cvt_pk_bf16_f32 v200, v176, v177
    v_cvt_pk_bf16_f32 v201, v178, v179
    v_cvt_pk_bf16_f32 v202, v180, v181
    v_cvt_pk_bf16_f32 v203, v182, v183
    buffer_store_dwordx4 v[200:203], v2, s[56:59], s99 offen offset:0 sc1
    s_waitcnt lgkmcnt(0)
    v_add_f32 v184, v184, v197
    v_add_f32 v185, v185, v198
    v_add_f32 v186, v186, v199
    v_cvt_pk_bf16_f32 v204, v184, v185
    v_cvt_pk_bf16_f32 v205, v186, v187
    v_cvt_pk_bf16_f32 v206, v188, v189
    v_cvt_pk_bf16_f32 v207, v190, v191
    buffer_store_dwordx4 v[204:207], v2, s[56:59], s99 offen offset:1024 sc1
    s_waitcnt vmcnt(25)
    v_mfma_f32_32x32x16_bf16 v[112:127], a[0:3], a[224:227], 0
    v_and_b32 v20, 31, v1
    v_lshrrev_b32 v21, 5, v1
    s_lshl_b32 s80, s8, 1
    s_add_u32 s80, s80, s11
    v_mfma_f32_32x32x16_bf16 v[144:159], a[4:7], a[224:227], 0
    s_mul_i32 s92, s80, 28672
    s_lshl_b32 s81, s9, 1
    s_add_u32 s81, s81, s10
    s_lshl_b32 s26, s81, 6
    s_add_u32 s100, s100, 1
    s_add_u32 s12, s12, 4096
    s_add_u32 s13, s13, 4096
    s_cmp_eq_u32 s100, 7
    s_cselect_b32 s12, s30, s12
    s_cselect_b32 s13, s31, s13
    buffer_load_dwordx4 a[224:227], v2, s[56:59], s12 offen offset:0 sc1
    s_waitcnt vmcnt(25)
    v_mfma_f32_32x32x16_bf16 v[128:143], a[0:3], a[228:231], 0
    s_add_u32 s92, s92, s26
    s_lshl_b32 s42, s3, 12
    s_add_u32 s42, s42, 114688
    v_lshrrev_b32 v22, 2, v1
    v_mfma_f32_32x32x16_bf16 v[160:175], a[4:7], a[228:231], 0
    v_mul_u32_u24 v11, 896, v22
    v_lshl_add_u32 v11, v30, 4, v11
    v_lshl_add_u32 v23, v21, 3, s26
    s_lshr_b32 s24, s96, 10
    buffer_load_dwordx4 a[228:231], v2, s[56:59], s13 offen offset:0 sc1
    s_waitcnt vmcnt(25)
    v_mfma_f32_32x32x16_bf16 v[112:127], a[8:11], a[232:235], v[112:127]
    s_mul_i32 s25, s11, 1792
    s_add_u32 s24, s24, s25
    s_add_u32 s24, s24, 1024
    v_mfma_f32_32x32x16_bf16 v[144:159], a[12:15], a[232:235], v[144:159]
    ds_read_b64_tr_b16 a[160:161], v38 offset:32768
    ds_read_b64_tr_b16 a[162:163], v38 offset:33792
    ds_read_b64_tr_b16 a[164:165], v39 offset:32768
    ds_read_b64_tr_b16 a[166:167], v39 offset:33792
    buffer_load_dwordx4 a[232:235], v2, s[56:59], s12 offen offset:1024 sc1
    s_waitcnt vmcnt(25)
    v_mfma_f32_32x32x16_bf16 v[128:143], a[8:11], a[236:239], v[128:143]
    ds_read_b64_tr_b16 a[168:169], v38 offset:34816
    ds_read_b64_tr_b16 a[170:171], v38 offset:35840
    ds_read_b64_tr_b16 a[172:173], v39 offset:34816
    ds_read_b64_tr_b16 a[174:175], v39 offset:35840
    v_mfma_f32_32x32x16_bf16 v[160:175], a[12:15], a[236:239], v[160:175]
    ds_read_b64_tr_b16 a[176:177], v38 offset:36864
    ds_read_b64_tr_b16 a[178:179], v38 offset:37888
    ds_read_b64_tr_b16 a[180:181], v39 offset:36864
    ds_read_b64_tr_b16 a[182:183], v39 offset:37888
    buffer_load_dwordx4 a[236:239], v2, s[56:59], s13 offen offset:1024 sc1
    s_waitcnt vmcnt(25)
    v_mfma_f32_32x32x16_bf16 v[112:127], a[16:19], a[240:243], v[112:127]
    ds_read_b64_tr_b16 a[184:185], v38 offset:38912
    ds_read_b64_tr_b16 a[186:187], v38 offset:39936
    ds_read_b64_tr_b16 a[188:189], v39 offset:38912
    ds_read_b64_tr_b16 a[190:191], v39 offset:39936
    v_mfma_f32_32x32x16_bf16 v[144:159], a[20:23], a[240:243], v[144:159]
    ds_read_b64_tr_b16 a[192:193], v40 offset:0
    ds_read_b64_tr_b16 a[194:195], v40 offset:1024
    ds_read_b64_tr_b16 a[196:197], v41 offset:0
    buffer_load_dwordx4 a[240:243], v2, s[56:59], s12 offen offset:2048 sc1
    s_waitcnt vmcnt(25)
    v_mfma_f32_32x32x16_bf16 v[128:143], a[16:19], a[244:247], v[128:143]
    ds_read_b64_tr_b16 a[198:199], v41 offset:1024
    ds_read_b64_tr_b16 a[200:201], v40 offset:2048
    ds_read_b64_tr_b16 a[202:203], v40 offset:3072
    ds_read_b64_tr_b16 a[204:205], v41 offset:2048
    v_mfma_f32_32x32x16_bf16 v[160:175], a[20:23], a[244:247], v[160:175]
    ds_read_b64_tr_b16 a[206:207], v41 offset:3072
    ds_read_b64_tr_b16 a[208:209], v40 offset:4096
    ds_read_b64_tr_b16 a[210:211], v40 offset:5120
    ds_read_b64_tr_b16 a[212:213], v41 offset:4096
    buffer_load_dwordx4 a[244:247], v2, s[56:59], s13 offen offset:2048 sc1
    s_waitcnt vmcnt(25)
    v_mfma_f32_32x32x16_bf16 v[112:127], a[24:27], a[248:251], v[112:127]
    ds_read_b64_tr_b16 a[214:215], v41 offset:5120
    ds_read_b64_tr_b16 a[216:217], v40 offset:6144
    ds_read_b64_tr_b16 a[218:219], v40 offset:7168
    ds_read_b64_tr_b16 a[220:221], v41 offset:6144
    v_mfma_f32_32x32x16_bf16 v[144:159], a[28:31], a[248:251], v[144:159]
    ds_read_b64_tr_b16 a[222:223], v41 offset:7168
    s_add_u32 m0, s42, 2048
    s_add_u32 s5, s92, 13312
    buffer_load_dwordx4 v11, s[44:47], s92 offen lds
    buffer_load_dwordx4 v11, s[44:47], s5 offen offset:1024 lds
    global_load_dwordx2 v[208:209], v23, s[22:23] offset:0
    buffer_load_dwordx4 a[248:251], v2, s[56:59], s12 offen offset:3072 sc1
    s_waitcnt vmcnt(28)
    v_mfma_f32_32x32x16_bf16 v[128:143], a[24:27], a[252:255], v[128:143]
    global_load_dwordx2 v[210:211], v23, s[22:23] offset:16
    global_load_dwordx2 v[212:213], v23, s[22:23] offset:32
    global_load_dwordx2 v[214:215], v23, s[22:23] offset:48
    v_lshl_add_u32 v23, v21, 2, v29
    v_mfma_f32_32x32x16_bf16 v[160:175], a[28:31], a[252:255], v[160:175]
    v_and_b32 v27, 1, v28
    v_lshlrev_b32 v10, 6, v23
    v_lshl_add_u32 v10, v27, 5, v10
    v_lshl_add_u32 v10, v30, 3, v10
    buffer_load_dwordx4 a[252:255], v2, s[56:59], s13 offen offset:3072 sc1
    s_waitcnt vmcnt(31)
    v_mfma_f32_32x32x16_bf16 v[112:127], a[32:35], v[48:51], v[112:127]
    v_add_u32 v10, s42, v10
    v_lshlrev_b32 v27, 11, v27
    v_lshl_add_u32 v27, v23, 5, v27
    v_lshl_add_u32 v27, v30, 3, v27
    v_mfma_f32_32x32x16_bf16 v[144:159], a[36:39], v[48:51], v[144:159]
    s_lshl_b32 s26, s11, 12
    s_lshl_b32 s5, s10, 10
    s_add_u32 s26, s26, s5
    s_add_u32 s26, s26, 131072
    s_add_u32 s100, s100, 1
    s_add_u32 s12, s12, 4096
    s_add_u32 s13, s13, 4096
    s_cmp_eq_u32 s100, 7
    s_cselect_b32 s12, s30, s12
    s_cselect_b32 s13, s31, s13
    buffer_load_dwordx4 v[48:51], v2, s[56:59], s12 offen offset:0 sc1
    s_waitcnt vmcnt(31)
    v_mfma_f32_32x32x16_bf16 v[128:143], a[32:35], v[52:55], v[128:143]
    v_add_u32 v27, s26, v27
    ds_read_b64_tr_b16 v[216:217], v27 offset:0
    ds_read_b64_tr_b16 v[218:219], v27 offset:256
    ds_read_b64_tr_b16 v[220:221], v27 offset:512
    v_mfma_f32_32x32x16_bf16 v[160:175], a[36:39], v[52:55], v[160:175]
    ds_read_b64_tr_b16 v[222:223], v27 offset:768
    v_lshlrev_b32 v23, 6, v20
    v_lshl_add_u32 v23, v21, 3, v23
    v_add_u32 v23, s42, v23
    buffer_load_dwordx4 v[52:55], v2, s[56:59], s13 offen offset:0 sc1
    s_waitcnt vmcnt(31)
    v_mfma_f32_32x32x16_bf16 v[112:127], a[40:43], v[56:59], v[112:127]
    s_waitcnt vmcnt(16)
    buffer_store_dword v32, v31, s[56:59], s24 offen sc1
    v_lshlrev_b32 v24, 16, v34
    v_and_b32 v25, s4, v35
    v_rcp_f32 v25, v25
    v_mfma_f32_32x32x16_bf16 v[144:159], a[44:47], v[56:59], v[144:159]
    v_mul_u32_u24 v4, 896, v20
    v_lshl_add_u32 v4, v21, 4, v4
    v_mul_f32 v26, v25, v25
    v_mul_f32 v24, v24, v25
    buffer_load_dwordx4 v[56:59], v2, s[56:59], s12 offen offset:1024 sc1
    v_mfma_f32_32x32x16_bf16 v[128:143], a[40:43], v[60:63], v[128:143]
    s_lshr_b32 s26, s8, 4
    s_mul_i32 s26, s26, 1792
    s_lshl_b32 s5, s81, 7
    s_add_u32 s93, s26, s5
    v_mfma_f32_32x32x16_bf16 v[160:175], a[44:47], v[60:63], v[160:175]
    s_add_u32 s93, s93, 1024
    v_lshlrev_b32 v5, 2, v20
    v_lshlrev_b32 v9, 12, v22
    v_lshl_add_u32 v9, v30, 4, v9
    buffer_load_dwordx4 v[60:63], v2, s[56:59], s13 offen offset:1024 sc1
    v_mfma_f32_32x32x16_bf16 v[112:127], a[48:51], v[64:67], v[112:127]
    s_lshl_b32 s94, s81, 17
    s_lshl_b32 s26, s80, 6
    s_add_u32 s94, s94, s26
    s_add_u32 s94, s94, 3145728
    v_mfma_f32_32x32x16_bf16 v[144:159], a[52:55], v[64:67], v[144:159]
    s_waitcnt lgkmcnt(0)
    s_barrier
    v_lshlrev_b32 v224, 16, v216
    v_and_b32 v225, s4, v216
    v_lshlrev_b32 v226, 16, v217
    buffer_load_dwordx4 v[64:67], v2, s[56:59], s12 offen offset:2048 sc1
    v_mfma_f32_32x32x16_bf16 v[128:143], a[48:51], v[68:71], v[128:143]
    v_and_b32 v227, s4, v217
    v_lshlrev_b32 v228, 16, v218
    v_and_b32 v229, s4, v218
    v_lshlrev_b32 v230, 16, v219
    v_mfma_f32_32x32x16_bf16 v[160:175], a[52:55], v[68:71], v[160:175]
    v_and_b32 v231, s4, v219
    v_lshlrev_b32 v232, 16, v220
    v_and_b32 v233, s4, v220
    v_lshlrev_b32 v234, 16, v221
    buffer_load_dwordx4 v[68:71], v2, s[56:59], s13 offen offset:2048 sc1
    v_mfma_f32_32x32x16_bf16 v[112:127], a[56:59], v[72:75], v[112:127]
    v_and_b32 v235, s4, v221
    v_lshlrev_b32 v236, 16, v222
    v_and_b32 v237, s4, v222
    v_lshlrev_b32 v238, 16, v223
    v_mfma_f32_32x32x16_bf16 v[144:159], a[60:63], v[72:75], v[144:159]
    v_and_b32 v239, s4, v223
    s_xor_b32 s25, s3, 1
    s_mul_i32 s25, s25, 12288
    s_add_u32 s25, s25, 0
    buffer_load_dwordx4 v[72:75], v2, s[56:59], s12 offen offset:3072 sc1
    v_mfma_f32_32x32x16_bf16 v[128:143], a[56:59], v[76:79], v[128:143]
    v_add_u32 v13, s25, v2
    s_xor_b32 s25, s3, 2
    s_mul_i32 s25, s25, 12288
    s_add_u32 s25, s25, 4096
    v_mfma_f32_32x32x16_bf16 v[160:175], a[60:63], v[76:79], v[160:175]
    v_add_u32 v14, s25, v2
    s_xor_b32 s25, s3, 3
    s_mul_i32 s25, s25, 12288
    s_add_u32 s25, s25, 8192
    buffer_load_dwordx4 v[76:79], v2, s[56:59], s13 offen offset:3072 sc1
    v_mfma_f32_32x32x16_bf16 v[112:127], a[64:67], v[80:83], v[112:127]
    v_add_u32 v15, s25, v2
    s_mul_i32 s25, s3, 12288
    v_add_u32 v12, s25, v2
    v_mul_f32 v27, 0xbfb8aa3b, v26
    v_mfma_f32_32x32x16_bf16 v[144:159], a[68:71], v[80:83], v[144:159]
    s_add_u32 s100, s100, 1
    s_add_u32 s12, s12, 4096
    s_add_u32 s13, s13, 4096
    s_cmp_eq_u32 s100, 7
    s_cselect_b32 s12, s30, s12
    s_cselect_b32 s13, s31, s13
    buffer_load_dwordx4 v[80:83], v2, s[56:59], s12 offen offset:0 sc1
    v_mfma_f32_32x32x16_bf16 v[128:143], a[64:67], v[84:87], v[128:143]
    v_mfma_f32_32x32x16_bf16 v[160:175], a[68:71], v[84:87], v[160:175]
    buffer_load_dwordx4 v[84:87], v2, s[56:59], s13 offen offset:0 sc1
    v_mfma_f32_32x32x16_bf16 v[112:127], a[72:75], v[88:91], v[112:127]
    v_mfma_f32_32x32x16_bf16 v[144:159], a[76:79], v[88:91], v[144:159]
    buffer_load_dwordx4 v[88:91], v2, s[56:59], s12 offen offset:1024 sc1
    v_mfma_f32_32x32x16_bf16 v[128:143], a[72:75], v[92:95], v[128:143]
    v_mfma_f32_32x32x16_bf16 v[160:175], a[76:79], v[92:95], v[160:175]
    buffer_load_dwordx4 v[92:95], v2, s[56:59], s13 offen offset:1024 sc1
    v_mfma_f32_32x32x16_bf16 v[112:127], a[80:83], v[96:99], v[112:127]
    v_mfma_f32_32x32x16_bf16 v[144:159], a[84:87], v[96:99], v[144:159]
    buffer_load_dwordx4 v[96:99], v2, s[56:59], s12 offen offset:2048 sc1
    v_mfma_f32_32x32x16_bf16 v[128:143], a[80:83], v[100:103], v[128:143]
    v_mfma_f32_32x32x16_bf16 v[160:175], a[84:87], v[100:103], v[160:175]
    buffer_load_dwordx4 v[100:103], v2, s[56:59], s13 offen offset:2048 sc1
    v_mfma_f32_32x32x16_bf16 v[112:127], a[88:91], v[104:107], v[112:127]
    v_mfma_f32_32x32x16_bf16 v[144:159], a[92:95], v[104:107], v[144:159]
    buffer_load_dwordx4 v[104:107], v2, s[56:59], s12 offen offset:3072 sc1
    v_mfma_f32_32x32x16_bf16 v[128:143], a[88:91], v[108:111], v[128:143]
    v_mfma_f32_32x32x16_bf16 v[160:175], a[92:95], v[108:111], v[160:175]
    buffer_load_dwordx4 v[108:111], v2, s[56:59], s13 offen offset:3072 sc1
    s_waitcnt vmcnt(30)
    v_mfma_f32_32x32x16_bf16 v[112:127], a[96:99], a[224:227], v[112:127]
    v_mfma_f32_32x32x16_bf16 v[144:159], a[100:103], a[224:227], v[144:159]
    s_add_u32 s100, s100, 1
    s_add_u32 s12, s12, 4096
    s_add_u32 s13, s13, 4096
    s_cmp_eq_u32 s100, 7
    s_cselect_b32 s12, s30, s12
    s_cselect_b32 s13, s31, s13
    buffer_load_dwordx4 a[224:227], v2, s[56:59], s12 offen offset:0 sc1
    s_waitcnt vmcnt(30)
    v_mfma_f32_32x32x16_bf16 v[128:143], a[96:99], a[228:231], v[128:143]
    v_mfma_f32_32x32x16_bf16 v[160:175], a[100:103], a[228:231], v[160:175]
    buffer_load_dwordx4 a[228:231], v2, s[56:59], s13 offen offset:0 sc1
    s_waitcnt vmcnt(30)
    v_mfma_f32_32x32x16_bf16 v[112:127], a[104:107], a[232:235], v[112:127]
    v_mfma_f32_32x32x16_bf16 v[144:159], a[108:111], a[232:235], v[144:159]
    buffer_load_dwordx4 a[232:235], v2, s[56:59], s12 offen offset:1024 sc1
    s_waitcnt vmcnt(30)
    v_mfma_f32_32x32x16_bf16 v[128:143], a[104:107], a[236:239], v[128:143]
    v_mfma_f32_32x32x16_bf16 v[160:175], a[108:111], a[236:239], v[160:175]
    buffer_load_dwordx4 a[236:239], v2, s[56:59], s13 offen offset:1024 sc1
    s_waitcnt vmcnt(30)
    v_mfma_f32_32x32x16_bf16 v[112:127], a[112:115], a[240:243], v[112:127]
    v_mfma_f32_32x32x16_bf16 v[144:159], a[116:119], a[240:243], v[144:159]
    buffer_load_dwordx4 a[240:243], v2, s[56:59], s12 offen offset:2048 sc1
    s_waitcnt vmcnt(30)
    v_mfma_f32_32x32x16_bf16 v[128:143], a[112:115], a[244:247], v[128:143]
    v_mfma_f32_32x32x16_bf16 v[160:175], a[116:119], a[244:247], v[160:175]
    buffer_load_dwordx4 a[244:247], v2, s[56:59], s13 offen offset:2048 sc1
    s_waitcnt vmcnt(27)
    v_mfma_f32_32x32x16_bf16 v[112:127], a[120:123], a[248:251], v[112:127]
    s_waitcnt vmcnt(24)
    ds_read_b64 v[240:241], v23 offset:2048
    ds_read_b64 v[242:243], v23 offset:2064
    ds_read_b64 v[244:245], v23 offset:2080
    v_mfma_f32_32x32x16_bf16 v[144:159], a[124:127], a[248:251], v[144:159]
    ds_read_b64 v[246:247], v23 offset:2096
    v_lshlrev_b32 v192, 16, v208
    v_and_b32 v193, s4, v208
    v_lshlrev_b32 v194, 16, v209
    buffer_load_dwordx4 a[248:251], v2, s[56:59], s12 offen offset:3072 sc1
    s_waitcnt vmcnt(24)
    v_mfma_f32_32x32x16_bf16 v[128:143], a[120:123], a[252:255], v[128:143]
    v_and_b32 v195, s4, v209
    v_lshlrev_b32 v196, 16, v210
    v_and_b32 v197, s4, v210
    v_lshlrev_b32 v198, 16, v211
    v_mfma_f32_32x32x16_bf16 v[160:175], a[124:127], a[252:255], v[160:175]
    v_and_b32 v199, s4, v211
    v_lshlrev_b32 v200, 16, v212
    v_and_b32 v201, s4, v212
    v_lshlrev_b32 v202, 16, v213
    buffer_load_dword v6, v5, s[56:59], s93 offen sc1
    buffer_load_dwordx4 a[252:255], v2, s[56:59], s13 offen offset:3072 sc1
    s_waitcnt vmcnt(25)
    v_mfma_f32_32x32x16_bf16 v[112:127], a[128:131], v[48:51], v[112:127]
    v_and_b32 v203, s4, v213
    v_lshlrev_b32 v204, 16, v214
    v_and_b32 v205, s4, v214
    v_lshlrev_b32 v206, 16, v215
    v_mfma_f32_32x32x16_bf16 v[144:159], a[132:135], v[48:51], v[144:159]
    v_and_b32 v207, s4, v215
    s_waitcnt lgkmcnt(0)
    v_lshlrev_b32 v176, 16, v240
    v_and_b32 v177, s4, v240
    s_waitcnt vmcnt(24)
    v_mfma_f32_32x32x16_bf16 v[128:143], a[128:131], v[52:55], v[128:143]
    v_lshlrev_b32 v178, 16, v241
    v_and_b32 v179, s4, v241
    v_lshlrev_b32 v180, 16, v242
    v_and_b32 v181, s4, v242
    v_mfma_f32_32x32x16_bf16 v[160:175], a[132:135], v[52:55], v[160:175]
    v_lshlrev_b32 v182, 16, v243
    v_and_b32 v183, s4, v243
    v_lshlrev_b32 v184, 16, v244
    v_and_b32 v185, s4, v244
    s_waitcnt vmcnt(22)
    v_mfma_f32_32x32x16_bf16 v[112:127], a[136:139], v[56:59], v[112:127]
    v_lshlrev_b32 v186, 16, v245
    v_and_b32 v187, s4, v245
    v_lshlrev_b32 v188, 16, v246
    v_and_b32 v189, s4, v246
    v_mfma_f32_32x32x16_bf16 v[144:159], a[140:143], v[56:59], v[144:159]
    v_lshlrev_b32 v190, 16, v247
    v_and_b32 v191, s4, v247
    v_fma_f32 v208, v176, v25, v24
    v_fma_f32 v209, v177, v25, v24
    s_waitcnt vmcnt(21)
    v_mfma_f32_32x32x16_bf16 v[128:143], a[136:139], v[60:63], v[128:143]
    v_fma_f32 v210, v178, v25, v24
    v_fma_f32 v211, v179, v25, v24
    v_fma_f32 v212, v180, v25, v24
    v_fma_f32 v213, v181, v25, v24
    v_mfma_f32_32x32x16_bf16 v[160:175], a[140:143], v[60:63], v[160:175]
    v_fma_f32 v214, v182, v25, v24
    v_fma_f32 v215, v183, v25, v24
    v_fma_f32 v216, v184, v25, v24
    v_fma_f32 v217, v185, v25, v24
    s_waitcnt vmcnt(20)
    v_mfma_f32_32x32x16_bf16 v[112:127], a[144:147], v[64:67], v[112:127]
    v_fma_f32 v218, v186, v25, v24
    v_fma_f32 v219, v187, v25, v24
    v_fma_f32 v220, v188, v25, v24
    v_fma_f32 v221, v189, v25, v24
    v_mfma_f32_32x32x16_bf16 v[144:159], a[148:151], v[64:67], v[144:159]
    v_fma_f32 v222, v190, v25, v24
    v_fma_f32 v223, v191, v25, v24
    s_waitcnt vmcnt(19)
    v_mfma_f32_32x32x16_bf16 v[128:143], a[144:147], v[68:71], v[128:143]
    v_mfma_f32_32x32x16_bf16 v[160:175], a[148:151], v[68:71], v[160:175]
    s_waitcnt vmcnt(18)
    v_mfma_f32_32x32x16_bf16 v[112:127], a[152:155], v[72:75], v[112:127]
    v_mfma_f32_32x32x16_bf16 v[144:159], a[156:159], v[72:75], v[144:159]
    s_waitcnt vmcnt(17)
    v_mfma_f32_32x32x16_bf16 v[128:143], a[152:155], v[76:79], v[128:143]
    v_mfma_f32_32x32x16_bf16 v[160:175], a[156:159], v[76:79], v[160:175]
    s_waitcnt vmcnt(16)
    v_mfma_f32_32x32x16_bf16 v[112:127], a[160:163], v[80:83], v[112:127]
    v_mfma_f32_32x32x16_bf16 v[144:159], a[164:167], v[80:83], v[144:159]
    s_waitcnt vmcnt(15)
    v_mfma_f32_32x32x16_bf16 v[128:143], a[160:163], v[84:87], v[128:143]
    v_mfma_f32_32x32x16_bf16 v[160:175], a[164:167], v[84:87], v[160:175]
    s_waitcnt vmcnt(1)
L_cyf:
    v_cmp_ne_u32 vcc, s32, v6
    s_cbranch_vccnz L_syf
L_ryf:
    s_mov_b32 m0, s42
    s_add_u32 s27, s94, 64512
    buffer_load_dwordx4 v9, s[56:59], s94 offen sc1 lds
    buffer_load_dwordx4 v9, s[56:59], s27 offen offset:1024 sc1 lds
    v_mfma_f32_32x32x16_bf16 v[112:127], a[168:171], v[88:91], v[112:127]
    v_mfma_f32_32x32x16_bf16 v[144:159], a[172:175], v[88:91], v[144:159]
    v_mfma_f32_32x32x16_bf16 v[128:143], a[168:171], v[92:95], v[128:143]
    v_mfma_f32_32x32x16_bf16 v[160:175], a[172:175], v[92:95], v[160:175]
    v_mfma_f32_32x32x16_bf16 v[112:127], a[176:179], v[96:99], v[112:127]
    v_mfma_f32_32x32x16_bf16 v[144:159], a[180:183], v[96:99], v[144:159]
    v_mfma_f32_32x32x16_bf16 v[128:143], a[176:179], v[100:103], v[128:143]
    v_mfma_f32_32x32x16_bf16 v[160:175], a[180:183], v[100:103], v[160:175]
    v_mfma_f32_32x32x16_bf16 v[112:127], a[184:187], v[104:107], v[112:127]
    v_mfma_f32_32x32x16_bf16 v[144:159], a[188:191], v[104:107], v[144:159]
    v_mfma_f32_32x32x16_bf16 v[128:143], a[184:187], v[108:111], v[128:143]
    v_mfma_f32_32x32x16_bf16 v[160:175], a[188:191], v[108:111], v[160:175]
    v_mfma_f32_32x32x16_bf16 v[160:175], a[196:199], a[228:231], v[160:175]
    v_mfma_f32_32x32x16_bf16 v[160:175], a[204:207], a[236:239], v[160:175]
    v_mfma_f32_32x32x16_bf16 v[160:175], a[212:215], a[244:247], v[160:175]
    s_waitcnt vmcnt(2)
    v_mfma_f32_32x32x16_bf16 v[160:175], a[220:223], a[252:255], v[160:175]
    s_waitcnt vmcnt(0)
    ds_read_b64_tr_b16 v[248:249], v10 offset:0
    ds_read_b64_tr_b16 v[250:251], v10 offset:512
    ds_read_b64_tr_b16 v[252:253], v10 offset:1024
    ds_read_b64_tr_b16 v[254:255], v10 offset:1536
    v_mfma_f32_32x32x16_bf16 v[144:159], a[196:199], a[224:227], v[144:159]
    s_nop 10
    ds_write_b128 v15, v[160:163] offset:0
    v_mfma_f32_32x32x16_bf16 v[144:159], a[204:207], a[232:235], v[144:159]
    ds_write_b128 v15, v[164:167] offset:1024
    v_mfma_f32_32x32x16_bf16 v[144:159], a[212:215], a[240:243], v[144:159]
    ds_write_b128 v15, v[168:171] offset:2048
    v_mfma_f32_32x32x16_bf16 v[144:159], a[220:223], a[248:251], v[144:159]
    ds_write_b128 v15, v[172:175] offset:3072
    v_mfma_f32_32x32x16_bf16 v[128:143], a[192:195], a[228:231], v[128:143]
    s_nop 10
    ds_write_b128 v14, v[144:147] offset:0
    s_waitcnt lgkmcnt(5)
    v_lshlrev_b32 v240, 16, v248
    v_and_b32 v241, s4, v248
    v_mfma_f32_32x32x16_bf16 v[128:143], a[200:203], a[236:239], v[128:143]
    ds_write_b128 v14, v[148:151] offset:1024
    v_add_f32 v224, v224, v240
    v_add_f32 v225, v225, v241
    v_lshlrev_b32 v240, 16, v249
    v_mfma_f32_32x32x16_bf16 v[128:143], a[208:211], a[244:247], v[128:143]
    ds_write_b128 v14, v[152:155] offset:2048
    v_and_b32 v241, s4, v249
    v_add_f32 v226, v226, v240
    v_add_f32 v227, v227, v241
    v_mfma_f32_32x32x16_bf16 v[128:143], a[216:219], a[252:255], v[128:143]
    ds_write_b128 v14, v[156:159] offset:3072
    v_lshlrev_b32 v240, 16, v250
    v_and_b32 v241, s4, v250
    v_add_f32 v228, v228, v240
    v_mfma_f32_32x32x16_bf16 v[112:127], a[192:195], a[224:227], v[112:127]
    s_nop 10
    ds_write_b128 v13, v[128:131] offset:0
    v_add_f32 v229, v229, v241
    v_lshlrev_b32 v240, 16, v251
    v_and_b32 v241, s4, v251
    v_mfma_f32_32x32x16_bf16 v[112:127], a[200:203], a[232:235], v[112:127]
    ds_write_b128 v13, v[132:135] offset:1024
    v_add_f32 v230, v230, v240
    v_add_f32 v231, v231, v241
    v_lshlrev_b32 v240, 16, v252
    v_mfma_f32_32x32x16_bf16 v[112:127], a[208:211], a[240:243], v[112:127]
    ds_write_b128 v13, v[136:139] offset:2048
    v_and_b32 v241, s4, v252
    v_add_f32 v232, v232, v240
    v_add_f32 v233, v233, v241
    v_mfma_f32_32x32x16_bf16 v[112:127], a[216:219], a[248:251], v[112:127]
    ds_write_b128 v13, v[140:143] offset:3072
    v_lshlrev_b32 v240, 16, v253
    v_and_b32 v241, s4, v253
    v_add_f32 v234, v234, v240
    v_add_f32 v235, v235, v241
    v_lshlrev_b32 v240, 16, v254
    v_and_b32 v241, s4, v254
    v_add_f32 v236, v236, v240
    v_add_f32 v237, v237, v241
    v_lshlrev_b32 v240, 16, v255
    v_and_b32 v241, s4, v255
    v_add_f32 v238, v238, v240
    v_add_f32 v239, v239, v241
    v_mul_f32 v208, v208, v224
    v_mul_f32 v209, v209, v225
    v_mul_f32 v210, v210, v226
    v_mul_f32 v211, v211, v227
    v_mul_f32 v212, v212, v228
    v_mul_f32 v213, v213, v229
    v_mul_f32 v214, v214, v230
    v_mul_f32 v215, v215, v231
    v_mul_f32 v216, v216, v232
    v_mul_f32 v217, v217, v233
    v_mul_f32 v218, v218, v234
    v_mul_f32 v219, v219, v235
    v_mul_f32 v220, v220, v236
    v_mul_f32 v221, v221, v237
    v_mul_f32 v222, v222, v238
    v_mul_f32 v223, v223, v239
    v_mul_f32 v224, 0xbfb8aa3b, v192
    v_mul_f32 v225, 0xbfb8aa3b, v193
    v_mul_f32 v226, 0xbfb8aa3b, v194
    v_mul_f32 v227, 0xbfb8aa3b, v195
    v_mul_f32 v228, 0xbfb8aa3b, v196
    v_mul_f32 v229, 0xbfb8aa3b, v197
    v_mul_f32 v230, 0xbfb8aa3b, v198
    v_mul_f32 v231, 0xbfb8aa3b, v199
    v_mul_f32 v232, 0xbfb8aa3b, v200
    v_mul_f32 v233, 0xbfb8aa3b, v201
    v_mul_f32 v234, 0xbfb8aa3b, v202
    v_mul_f32 v235, 0xbfb8aa3b, v203
    v_mul_f32 v236, 0xbfb8aa3b, v204
    v_mul_f32 v237, 0xbfb8aa3b, v205
    v_mul_f32 v238, 0xbfb8aa3b, v206
    v_mul_f32 v239, 0xbfb8aa3b, v207
    s_waitcnt lgkmcnt(0)
    s_barrier
    ds_read_b128 v[48:51], v12 offset:0
    ds_read_b128 v[52:55], v12 offset:1024
    ds_read_b128 v[56:59], v12 offset:2048
    ds_read_b128 v[60:63], v12 offset:3072
    ds_read_b128 v[64:67], v12 offset:4096
    ds_read_b128 v[68:71], v12 offset:5120
    ds_read_b128 v[72:75], v12 offset:6144
    ds_read_b128 v[76:79], v12 offset:7168
    ds_read_b128 v[80:83], v12 offset:8192
    ds_read_b128 v[84:87], v12 offset:9216
    ds_read_b128 v[88:91], v12 offset:10240
    ds_read_b128 v[92:95], v12 offset:11264
    s_waitcnt lgkmcnt(8)
    v_pk_add_f32 v[112:113], v[112:113], v[48:49]
    v_pk_add_f32 v[114:115], v[114:115], v[50:51]
    v_pk_add_f32 v[116:117], v[116:117], v[52:53]
    v_pk_add_f32 v[118:119], v[118:119], v[54:55]
    v_pk_add_f32 v[120:121], v[120:121], v[56:57]
    v_pk_add_f32 v[122:123], v[122:123], v[58:59]
    v_pk_add_f32 v[124:125], v[124:125], v[60:61]
    v_pk_add_f32 v[126:127], v[126:127], v[62:63]
    s_waitcnt lgkmcnt(4)
    v_pk_add_f32 v[112:113], v[112:113], v[64:65]
    v_pk_add_f32 v[114:115], v[114:115], v[66:67]
    v_pk_add_f32 v[116:117], v[116:117], v[68:69]
    v_pk_add_f32 v[118:119], v[118:119], v[70:71]
    v_pk_add_f32 v[120:121], v[120:121], v[72:73]
    v_pk_add_f32 v[122:123], v[122:123], v[74:75]
    v_pk_add_f32 v[124:125], v[124:125], v[76:77]
    v_pk_add_f32 v[126:127], v[126:127], v[78:79]
    s_waitcnt lgkmcnt(0)
    v_pk_add_f32 v[112:113], v[112:113], v[80:81]
    v_pk_add_f32 v[114:115], v[114:115], v[82:83]
    v_pk_add_f32 v[116:117], v[116:117], v[84:85]
    v_pk_add_f32 v[118:119], v[118:119], v[86:87]
    v_pk_add_f32 v[120:121], v[120:121], v[88:89]
    v_pk_add_f32 v[122:123], v[122:123], v[90:91]
    v_pk_add_f32 v[124:125], v[124:125], v[92:93]
    v_pk_add_f32 v[126:127], v[126:127], v[94:95]
    v_fmac_f32 v224, v112, v27
    v_fmac_f32 v225, v113, v27
    v_fmac_f32 v226, v114, v27
    v_fmac_f32 v227, v115, v27
    v_fmac_f32 v228, v116, v27
    v_fmac_f32 v229, v117, v27
    v_fmac_f32 v230, v118, v27
    v_fmac_f32 v231, v119, v27
    v_fmac_f32 v232, v120, v27
    v_fmac_f32 v233, v121, v27
    v_fmac_f32 v234, v122, v27
    v_fmac_f32 v235, v123, v27
    v_fmac_f32 v236, v124, v27
    v_fmac_f32 v237, v125, v27
    v_fmac_f32 v238, v126, v27
    v_fmac_f32 v239, v127, v27
    v_exp_f32 v224, v224
    v_exp_f32 v225, v225
    v_exp_f32 v226, v226
    v_exp_f32 v227, v227
    v_exp_f32 v228, v228
    v_exp_f32 v229, v229
    v_exp_f32 v230, v230
    v_exp_f32 v231, v231
    v_exp_f32 v232, v232
    v_exp_f32 v233, v233
    v_exp_f32 v234, v234
    v_exp_f32 v235, v235
    v_exp_f32 v236, v236
    v_exp_f32 v237, v237
    v_exp_f32 v238, v238
    v_exp_f32 v239, v239
    v_fmac_f32 v192, v112, v26
    v_fmac_f32 v193, v113, v26
    v_fmac_f32 v194, v114, v26
    v_fmac_f32 v195, v115, v26
    v_fmac_f32 v196, v116, v26
    v_fmac_f32 v197, v117, v26
    v_fmac_f32 v198, v118, v26
    v_fmac_f32 v199, v119, v26
    v_fmac_f32 v200, v120, v26
    v_fmac_f32 v201, v121, v26
    v_fmac_f32 v202, v122, v26
    v_fmac_f32 v203, v123, v26
    v_fmac_f32 v204, v124, v26
    v_fmac_f32 v205, v125, v26
    v_fmac_f32 v206, v126, v26
    v_fmac_f32 v207, v127, v26
    v_add_f32 v224, 1.0, v224
    v_add_f32 v225, 1.0, v225
    v_add_f32 v226, 1.0, v226
    v_add_f32 v227, 1.0, v227
    v_add_f32 v228, 1.0, v228
    v_add_f32 v229, 1.0, v229
    v_add_f32 v230, 1.0, v230
    v_add_f32 v231, 1.0, v231
    v_add_f32 v232, 1.0, v232
    v_add_f32 v233, 1.0, v233
    v_add_f32 v234, 1.0, v234
    v_add_f32 v235, 1.0, v235
    v_add_f32 v236, 1.0, v236
    v_add_f32 v237, 1.0, v237
    v_add_f32 v238, 1.0, v238
    v_add_f32 v239, 1.0, v239
    v_rcp_f32 v224, v224
    v_rcp_f32 v225, v225
    v_rcp_f32 v226, v226
    v_rcp_f32 v227, v227
    v_rcp_f32 v228, v228
    v_rcp_f32 v229, v229
    v_rcp_f32 v230, v230
    v_rcp_f32 v231, v231
    v_rcp_f32 v232, v232
    v_rcp_f32 v233, v233
    v_rcp_f32 v234, v234
    v_rcp_f32 v235, v235
    v_rcp_f32 v236, v236
    v_rcp_f32 v237, v237
    v_rcp_f32 v238, v238
    v_rcp_f32 v239, v239
    v_mul_f32 v208, v208, v192
    v_mul_f32 v209, v209, v193
    v_mul_f32 v210, v210, v194
    v_mul_f32 v211, v211, v195
    v_mul_f32 v212, v212, v196
    v_mul_f32 v213, v213, v197
    v_mul_f32 v214, v214, v198
    v_mul_f32 v215, v215, v199
    v_mul_f32 v216, v216, v200
    v_mul_f32 v217, v217, v201
    v_mul_f32 v218, v218, v202
    v_mul_f32 v219, v219, v203
    v_mul_f32 v220, v220, v204
    v_mul_f32 v221, v221, v205
    v_mul_f32 v222, v222, v206
    v_mul_f32 v223, v223, v207
    v_fmac_f32 v176, v208, v224
    v_fmac_f32 v177, v209, v225
    v_fmac_f32 v178, v210, v226
    v_fmac_f32 v179, v211, v227
    v_fmac_f32 v180, v212, v228
    v_fmac_f32 v181, v213, v229
    v_fmac_f32 v182, v214, v230
    v_fmac_f32 v183, v215, v231
    v_fmac_f32 v184, v216, v232
    v_fmac_f32 v185, v217, v233
    v_fmac_f32 v186, v218, v234
    v_fmac_f32 v187, v219, v235
    v_fmac_f32 v188, v220, v236
    v_fmac_f32 v189, v221, v237
    v_fmac_f32 v190, v222, v238
    v_fmac_f32 v191, v223, v239
    v_cvt_pk_bf16_f32 v240, v176, v177
    v_cvt_pk_bf16_f32 v241, v178, v179
    v_cvt_pk_bf16_f32 v242, v180, v181
    v_cvt_pk_bf16_f32 v243, v182, v183
    v_cvt_pk_bf16_f32 v244, v184, v185
    v_cvt_pk_bf16_f32 v245, v186, v187
    v_cvt_pk_bf16_f32 v246, v188, v189
    v_cvt_pk_bf16_f32 v247, v190, v191
    s_nop 1
    v_permlane32_swap_b32 v240, v242
    v_permlane32_swap_b32 v241, v243
    v_permlane32_swap_b32 v244, v246
    v_permlane32_swap_b32 v245, v247
    s_nop 1
    buffer_store_dwordx4 v[240:243], v4, s[72:75], s92 offen offset:0
    buffer_store_dwordx4 v[244:247], v4, s[72:75], s92 offen offset:32
L_end:
    s_endpgm
L_stokm:
    s_cmp_eq_u32 s40, 0
    s_cbranch_scc1 L_rtokm
    s_sub_u32 s40, s40, 1
    s_sleep 2
    buffer_load_dword v32, v31, s[76:79], 0 offen sc1
    s_waitcnt vmcnt(0)
    s_branch L_ctokm
L_skv:
    s_cmp_eq_u32 s40, 0
    s_cbranch_scc1 L_rkv
    s_sub_u32 s40, s40, 1
    buffer_load_dword v37, v36, s[56:59], s83 offen sc1
    s_waitcnt vmcnt(0)
    s_branch L_ckv
L_sgr:
    s_cmp_eq_u32 s40, 0
    s_cbranch_scc1 L_rgr
    s_sub_u32 s40, s40, 1
    buffer_load_dwordx4 v[176:179], v47, s[56:59], s80 offen sc1
    buffer_load_dwordx4 v[180:183], v47, s[56:59], s80 offen offset:512 sc1
    buffer_load_dwordx4 v[184:187], v47, s[56:59], s81 offen sc1
    buffer_load_dwordx4 v[188:191], v47, s[56:59], s81 offen offset:512 sc1
    buffer_load_dwordx4 v[192:195], v47, s[56:59], s82 offen sc1
    s_waitcnt vmcnt(0)
    s_branch L_cgr
L_shf:
    s_cmp_eq_u32 s40, 0
    s_cbranch_scc1 L_rhf
    s_sub_u32 s40, s40, 1
    buffer_load_dword v8, v7, s[56:59], s97 offen sc1
    s_waitcnt vmcnt(0)
    s_branch L_chf
L_syf:
    s_cmp_eq_u32 s40, 0
    s_cbranch_scc1 L_ryf
    s_sub_u32 s40, s40, 1
    buffer_load_dword v6, v5, s[56:59], s93 offen sc1
    s_waitcnt vmcnt(0)
    s_branch L_cyf
L_helper:
    s_load_dwordx2 s[76:77], s[0:1], 96
    s_load_dwordx2 s[56:57], s[0:1], 104
    s_load_dwordx2 s[20:21], s[0:1], 64
    s_memrealtime s[38:39]
    s_getpc_b64 s[34:35]
L_pc:
    s_sub_u32 s34, s34, L_pc-recurrent_scan__ssm_conv_h3__dense_activation_squared_relu__prompt_kernel
    s_subb_u32 s35, s35, 0
    v_lshlrev_b32 v144, 4, v0
    global_load_dwordx4 v[148:151], v144, s[34:35]
    v_add_u32 v144, 4096, v144
    global_load_dwordx4 v[148:151], v144, s[34:35]
    v_add_u32 v144, 4096, v144
    global_load_dwordx4 v[148:151], v144, s[34:35]
    v_add_u32 v144, 4096, v144
    global_load_dwordx4 v[148:151], v144, s[34:35]
    v_add_u32 v144, 4096, v144
    global_load_dwordx4 v[148:151], v144, s[34:35]
    v_add_u32 v144, 4096, v144
    global_load_dwordx4 v[148:151], v144, s[34:35]
    s_add_u32 s24, s2, 2
    s_and_b32 s24, s24, 7
    s_lshl_b32 s25, s24, 1
    s_lshr_b32 s26, s2, 3
    s_add_u32 s6, s25, s26
    s_and_b32 s25, s24, 1
    s_mul_i32 s25, s25, 7
    s_sub_u32 s26, s2, 16
    s_lshr_b32 s26, s26, 1
    s_add_u32 s7, s25, s26
    s_mov_b32 s46, 1835008
    s_mov_b32 s47, 0x20000
    s_mov_b32 s50, 1605632
    s_mov_b32 s51, 0x20000
    v_lshrrev_b32 v178, 1, v180
    v_xor_b32 v179, v177, v178
    v_lshl_add_u32 v4, v179, 4, v176
    v_xor_b32 v5, 64, v4
    v_add_u32 v5, 6144, v5
    v_add_u32 v6, 12288, v4
    v_add_u32 v7, 12288, v5
    v_lshrrev_b32 v28, 4, v1
    v_mul_u32_u24 v178, 3584, v28
    v_and_b32 v179, 15, v1
    v_lshlrev_b32 v183, 2, v28
    v_xor_b32 v179, v179, v183
    v_lshl_add_u32 v8, v179, 4, v178
    v_add_u32 v9, 13312, v8
    v_add_u32 v10, 26624, v8
    v_add_u32 v11, 39936, v8
    s_lshl_b32 s26, s6, 2
    s_add_u32 s26, s26, s3
    s_mul_i32 s12, s26, 28672
    s_mul_i32 s13, s3, 57344
    s_lshl_b32 s26, s7, 8
    s_add_u32 s13, s13, s26
    s_lshl_b32 s30, s3, 12
    s_add_u32 s31, s30, 16384
    s_mov_b32 s78, 256
    s_mov_b32 s79, 0x20000
    s_mov_b32 s58, 268435456
    s_mov_b32 s59, 0x20000
    v_mov_b32 v31, 0
    s_mov_b32 s4, 0xffff0000
    s_mov_b32 s40, 200000
    v_lshlrev_b32 v2, 4, v1
    v_bfe_u32 v29, v1, 2, 2
    v_and_b32 v30, 3, v1
    s_mov_b32 s33, 0x3f803f80
    s_movk_i32 s99, 128
    s_mov_b32 s43, 0
    s_waitcnt lgkmcnt(0)
    s_or_b32 s5, s2, s3
    s_cmp_lg_u32 s5, 0
    s_cbranch_scc1 L_notok
    s_or_b32 s5, s38, 1
    v_mov_b32 v32, s5
    buffer_store_dword v32, v31, s[76:79], 0 offen sc1
L_notok:
    s_cmp_lt_u32 s2, 16
    s_cbranch_scc1 L_hs_sel
    s_mov_b64 s[44:45], s[48:49]
    s_mov_b32 s46, 1605632
    v_mov_b32 v4, v8
    v_mov_b32 v5, v9
    v_mov_b32 v6, v10
    v_mov_b32 v7, v11
    s_mov_b32 s12, s13
    s_mov_b32 s99, 229376
L_hs_sel:
    s_mov_b32 s28, 0
L_h_pre:
    s_add_u32 m0, s43, s30
    s_add_u32 s43, s43, 16384
    buffer_load_dwordx4 v4, s[44:47], s12 offen offset:0 lds
    buffer_load_dwordx4 v5, s[44:47], s12 offen offset:1024 lds
    buffer_load_dwordx4 v6, s[44:47], s12 offen offset:2048 lds
    buffer_load_dwordx4 v7, s[44:47], s12 offen offset:3072 lds
    s_add_u32 s12, s12, s99
    s_add_u32 s28, s28, 1
    s_cmp_lt_u32 s28, 7
    s_cbranch_scc1 L_h_pre
    buffer_load_dword v32, v31, s[76:79], 0 offen sc1
    v_mov_b32 v48, 0
    v_mov_b32 v49, 0
    v_mov_b32 v50, 0
    v_mov_b32 v51, 0
    v_mov_b32 v52, 0
    v_mov_b32 v53, 0
    v_mov_b32 v54, 0
    v_mov_b32 v55, 0
    s_cmp_lt_u32 s2, 16
    s_cbranch_scc0 L_hcs
    v_and_b32 v176, 31, v1
    v_lshrrev_b32 v177, 5, v1
    v_bfe_u32 v178, v1, 1, 3
    v_xor_b32 v177, v177, v178
    v_lshlrev_b32 v177, 4, v177
    v_lshl_add_u32 v177, v176, 7, v177
    v_add_u32 v16, s30, v177
    v_xor_b32 v17, 32, v16
    v_xor_b32 v18, 64, v16
    v_xor_b32 v19, 96, v16
    s_waitcnt vmcnt(25)
    ds_read_b128 v[112:115], v16 offset:0
    ds_read_b128 v[116:119], v17 offset:0
    ds_read_b128 v[120:123], v18 offset:0
    ds_read_b128 v[124:127], v19 offset:0
    s_waitcnt lgkmcnt(3)
    v_dot2c_f32_bf16 v48, s33, v112
    v_dot2c_f32_bf16 v50, v112, v112
    v_dot2c_f32_bf16 v49, s33, v113
    v_dot2c_f32_bf16 v51, v113, v113
    v_dot2c_f32_bf16 v48, s33, v114
    v_dot2c_f32_bf16 v50, v114, v114
    v_dot2c_f32_bf16 v49, s33, v115
    v_dot2c_f32_bf16 v51, v115, v115
    s_waitcnt lgkmcnt(2)
    v_dot2c_f32_bf16 v48, s33, v116
    v_dot2c_f32_bf16 v50, v116, v116
    v_dot2c_f32_bf16 v49, s33, v117
    v_dot2c_f32_bf16 v51, v117, v117
    v_dot2c_f32_bf16 v48, s33, v118
    v_dot2c_f32_bf16 v50, v118, v118
    v_dot2c_f32_bf16 v49, s33, v119
    v_dot2c_f32_bf16 v51, v119, v119
    s_waitcnt lgkmcnt(1)
    v_dot2c_f32_bf16 v48, s33, v120
    v_dot2c_f32_bf16 v50, v120, v120
    v_dot2c_f32_bf16 v49, s33, v121
    v_dot2c_f32_bf16 v51, v121, v121
    v_dot2c_f32_bf16 v48, s33, v122
    v_dot2c_f32_bf16 v50, v122, v122
    v_dot2c_f32_bf16 v49, s33, v123
    v_dot2c_f32_bf16 v51, v123, v123
    s_waitcnt lgkmcnt(0)
    v_dot2c_f32_bf16 v48, s33, v124
    v_dot2c_f32_bf16 v50, v124, v124
    v_dot2c_f32_bf16 v49, s33, v125
    v_dot2c_f32_bf16 v51, v125, v125
    v_dot2c_f32_bf16 v48, s33, v126
    v_dot2c_f32_bf16 v50, v126, v126
    v_dot2c_f32_bf16 v49, s33, v127
    v_dot2c_f32_bf16 v51, v127, v127
    s_waitcnt vmcnt(21)
    ds_read_b128 v[112:115], v16 offset:16384
    ds_read_b128 v[116:119], v17 offset:16384
    ds_read_b128 v[120:123], v18 offset:16384
    ds_read_b128 v[124:127], v19 offset:16384
    s_waitcnt lgkmcnt(3)
    v_dot2c_f32_bf16 v48, s33, v112
    v_dot2c_f32_bf16 v50, v112, v112
    v_dot2c_f32_bf16 v49, s33, v113
    v_dot2c_f32_bf16 v51, v113, v113
    v_dot2c_f32_bf16 v48, s33, v114
    v_dot2c_f32_bf16 v50, v114, v114
    v_dot2c_f32_bf16 v49, s33, v115
    v_dot2c_f32_bf16 v51, v115, v115
    s_waitcnt lgkmcnt(2)
    v_dot2c_f32_bf16 v48, s33, v116
    v_dot2c_f32_bf16 v50, v116, v116
    v_dot2c_f32_bf16 v49, s33, v117
    v_dot2c_f32_bf16 v51, v117, v117
    v_dot2c_f32_bf16 v48, s33, v118
    v_dot2c_f32_bf16 v50, v118, v118
    v_dot2c_f32_bf16 v49, s33, v119
    v_dot2c_f32_bf16 v51, v119, v119
    s_waitcnt lgkmcnt(1)
    v_dot2c_f32_bf16 v48, s33, v120
    v_dot2c_f32_bf16 v50, v120, v120
    v_dot2c_f32_bf16 v49, s33, v121
    v_dot2c_f32_bf16 v51, v121, v121
    v_dot2c_f32_bf16 v48, s33, v122
    v_dot2c_f32_bf16 v50, v122, v122
    v_dot2c_f32_bf16 v49, s33, v123
    v_dot2c_f32_bf16 v51, v123, v123
    s_waitcnt lgkmcnt(0)
    v_dot2c_f32_bf16 v48, s33, v124
    v_dot2c_f32_bf16 v50, v124, v124
    v_dot2c_f32_bf16 v49, s33, v125
    v_dot2c_f32_bf16 v51, v125, v125
    v_dot2c_f32_bf16 v48, s33, v126
    v_dot2c_f32_bf16 v50, v126, v126
    v_dot2c_f32_bf16 v49, s33, v127
    v_dot2c_f32_bf16 v51, v127, v127
    s_waitcnt vmcnt(17)
    ds_read_b128 v[112:115], v16 offset:32768
    ds_read_b128 v[116:119], v17 offset:32768
    ds_read_b128 v[120:123], v18 offset:32768
    ds_read_b128 v[124:127], v19 offset:32768
    s_waitcnt lgkmcnt(3)
    v_dot2c_f32_bf16 v48, s33, v112
    v_dot2c_f32_bf16 v50, v112, v112
    v_dot2c_f32_bf16 v49, s33, v113
    v_dot2c_f32_bf16 v51, v113, v113
    v_dot2c_f32_bf16 v48, s33, v114
    v_dot2c_f32_bf16 v50, v114, v114
    v_dot2c_f32_bf16 v49, s33, v115
    v_dot2c_f32_bf16 v51, v115, v115
    s_waitcnt lgkmcnt(2)
    v_dot2c_f32_bf16 v48, s33, v116
    v_dot2c_f32_bf16 v50, v116, v116
    v_dot2c_f32_bf16 v49, s33, v117
    v_dot2c_f32_bf16 v51, v117, v117
    v_dot2c_f32_bf16 v48, s33, v118
    v_dot2c_f32_bf16 v50, v118, v118
    v_dot2c_f32_bf16 v49, s33, v119
    v_dot2c_f32_bf16 v51, v119, v119
    s_waitcnt lgkmcnt(1)
    v_dot2c_f32_bf16 v48, s33, v120
    v_dot2c_f32_bf16 v50, v120, v120
    v_dot2c_f32_bf16 v49, s33, v121
    v_dot2c_f32_bf16 v51, v121, v121
    v_dot2c_f32_bf16 v48, s33, v122
    v_dot2c_f32_bf16 v50, v122, v122
    v_dot2c_f32_bf16 v49, s33, v123
    v_dot2c_f32_bf16 v51, v123, v123
    s_waitcnt lgkmcnt(0)
    v_dot2c_f32_bf16 v48, s33, v124
    v_dot2c_f32_bf16 v50, v124, v124
    v_dot2c_f32_bf16 v49, s33, v125
    v_dot2c_f32_bf16 v51, v125, v125
    v_dot2c_f32_bf16 v48, s33, v126
    v_dot2c_f32_bf16 v50, v126, v126
    v_dot2c_f32_bf16 v49, s33, v127
    v_dot2c_f32_bf16 v51, v127, v127
    s_waitcnt vmcnt(13)
    ds_read_b128 v[112:115], v16 offset:49152
    ds_read_b128 v[116:119], v17 offset:49152
    ds_read_b128 v[120:123], v18 offset:49152
    ds_read_b128 v[124:127], v19 offset:49152
    s_waitcnt lgkmcnt(3)
    v_dot2c_f32_bf16 v48, s33, v112
    v_dot2c_f32_bf16 v50, v112, v112
    v_dot2c_f32_bf16 v49, s33, v113
    v_dot2c_f32_bf16 v51, v113, v113
    v_dot2c_f32_bf16 v48, s33, v114
    v_dot2c_f32_bf16 v50, v114, v114
    v_dot2c_f32_bf16 v49, s33, v115
    v_dot2c_f32_bf16 v51, v115, v115
    s_waitcnt lgkmcnt(2)
    v_dot2c_f32_bf16 v48, s33, v116
    v_dot2c_f32_bf16 v50, v116, v116
    v_dot2c_f32_bf16 v49, s33, v117
    v_dot2c_f32_bf16 v51, v117, v117
    v_dot2c_f32_bf16 v48, s33, v118
    v_dot2c_f32_bf16 v50, v118, v118
    v_dot2c_f32_bf16 v49, s33, v119
    v_dot2c_f32_bf16 v51, v119, v119
    s_waitcnt lgkmcnt(1)
    v_dot2c_f32_bf16 v48, s33, v120
    v_dot2c_f32_bf16 v50, v120, v120
    v_dot2c_f32_bf16 v49, s33, v121
    v_dot2c_f32_bf16 v51, v121, v121
    v_dot2c_f32_bf16 v48, s33, v122
    v_dot2c_f32_bf16 v50, v122, v122
    v_dot2c_f32_bf16 v49, s33, v123
    v_dot2c_f32_bf16 v51, v123, v123
    s_waitcnt lgkmcnt(0)
    v_dot2c_f32_bf16 v48, s33, v124
    v_dot2c_f32_bf16 v50, v124, v124
    v_dot2c_f32_bf16 v49, s33, v125
    v_dot2c_f32_bf16 v51, v125, v125
    v_dot2c_f32_bf16 v48, s33, v126
    v_dot2c_f32_bf16 v50, v126, v126
    v_dot2c_f32_bf16 v49, s33, v127
    v_dot2c_f32_bf16 v51, v127, v127
    s_waitcnt vmcnt(9)
    v_add_u32 v16, 65536, v16
    v_add_u32 v17, 65536, v17
    v_add_u32 v18, 65536, v18
    v_add_u32 v19, 65536, v19
    ds_read_b128 v[112:115], v16 offset:0
    ds_read_b128 v[116:119], v17 offset:0
    ds_read_b128 v[120:123], v18 offset:0
    ds_read_b128 v[124:127], v19 offset:0
    s_waitcnt lgkmcnt(3)
    v_dot2c_f32_bf16 v48, s33, v112
    v_dot2c_f32_bf16 v50, v112, v112
    v_dot2c_f32_bf16 v49, s33, v113
    v_dot2c_f32_bf16 v51, v113, v113
    v_dot2c_f32_bf16 v48, s33, v114
    v_dot2c_f32_bf16 v50, v114, v114
    v_dot2c_f32_bf16 v49, s33, v115
    v_dot2c_f32_bf16 v51, v115, v115
    s_waitcnt lgkmcnt(2)
    v_dot2c_f32_bf16 v48, s33, v116
    v_dot2c_f32_bf16 v50, v116, v116
    v_dot2c_f32_bf16 v49, s33, v117
    v_dot2c_f32_bf16 v51, v117, v117
    v_dot2c_f32_bf16 v48, s33, v118
    v_dot2c_f32_bf16 v50, v118, v118
    v_dot2c_f32_bf16 v49, s33, v119
    v_dot2c_f32_bf16 v51, v119, v119
    s_waitcnt lgkmcnt(1)
    v_dot2c_f32_bf16 v48, s33, v120
    v_dot2c_f32_bf16 v50, v120, v120
    v_dot2c_f32_bf16 v49, s33, v121
    v_dot2c_f32_bf16 v51, v121, v121
    v_dot2c_f32_bf16 v48, s33, v122
    v_dot2c_f32_bf16 v50, v122, v122
    v_dot2c_f32_bf16 v49, s33, v123
    v_dot2c_f32_bf16 v51, v123, v123
    s_waitcnt lgkmcnt(0)
    v_dot2c_f32_bf16 v48, s33, v124
    v_dot2c_f32_bf16 v50, v124, v124
    v_dot2c_f32_bf16 v49, s33, v125
    v_dot2c_f32_bf16 v51, v125, v125
    v_dot2c_f32_bf16 v48, s33, v126
    v_dot2c_f32_bf16 v50, v126, v126
    v_dot2c_f32_bf16 v49, s33, v127
    v_dot2c_f32_bf16 v51, v127, v127
    s_waitcnt vmcnt(5)
    ds_read_b128 v[112:115], v16 offset:16384
    ds_read_b128 v[116:119], v17 offset:16384
    ds_read_b128 v[120:123], v18 offset:16384
    ds_read_b128 v[124:127], v19 offset:16384
    s_waitcnt lgkmcnt(3)
    v_dot2c_f32_bf16 v48, s33, v112
    v_dot2c_f32_bf16 v50, v112, v112
    v_dot2c_f32_bf16 v49, s33, v113
    v_dot2c_f32_bf16 v51, v113, v113
    v_dot2c_f32_bf16 v48, s33, v114
    v_dot2c_f32_bf16 v50, v114, v114
    v_dot2c_f32_bf16 v49, s33, v115
    v_dot2c_f32_bf16 v51, v115, v115
    s_waitcnt lgkmcnt(2)
    v_dot2c_f32_bf16 v48, s33, v116
    v_dot2c_f32_bf16 v50, v116, v116
    v_dot2c_f32_bf16 v49, s33, v117
    v_dot2c_f32_bf16 v51, v117, v117
    v_dot2c_f32_bf16 v48, s33, v118
    v_dot2c_f32_bf16 v50, v118, v118
    v_dot2c_f32_bf16 v49, s33, v119
    v_dot2c_f32_bf16 v51, v119, v119
    s_waitcnt lgkmcnt(1)
    v_dot2c_f32_bf16 v48, s33, v120
    v_dot2c_f32_bf16 v50, v120, v120
    v_dot2c_f32_bf16 v49, s33, v121
    v_dot2c_f32_bf16 v51, v121, v121
    v_dot2c_f32_bf16 v48, s33, v122
    v_dot2c_f32_bf16 v50, v122, v122
    v_dot2c_f32_bf16 v49, s33, v123
    v_dot2c_f32_bf16 v51, v123, v123
    s_waitcnt lgkmcnt(0)
    v_dot2c_f32_bf16 v48, s33, v124
    v_dot2c_f32_bf16 v50, v124, v124
    v_dot2c_f32_bf16 v49, s33, v125
    v_dot2c_f32_bf16 v51, v125, v125
    v_dot2c_f32_bf16 v48, s33, v126
    v_dot2c_f32_bf16 v50, v126, v126
    v_dot2c_f32_bf16 v49, s33, v127
    v_dot2c_f32_bf16 v51, v127, v127
    s_waitcnt vmcnt(1)
    ds_read_b128 v[112:115], v16 offset:32768
    ds_read_b128 v[116:119], v17 offset:32768
    ds_read_b128 v[120:123], v18 offset:32768
    ds_read_b128 v[124:127], v19 offset:32768
    s_waitcnt lgkmcnt(3)
    v_dot2c_f32_bf16 v48, s33, v112
    v_dot2c_f32_bf16 v50, v112, v112
    v_dot2c_f32_bf16 v49, s33, v113
    v_dot2c_f32_bf16 v51, v113, v113
    v_dot2c_f32_bf16 v48, s33, v114
    v_dot2c_f32_bf16 v50, v114, v114
    v_dot2c_f32_bf16 v49, s33, v115
    v_dot2c_f32_bf16 v51, v115, v115
    s_waitcnt lgkmcnt(2)
    v_dot2c_f32_bf16 v48, s33, v116
    v_dot2c_f32_bf16 v50, v116, v116
    v_dot2c_f32_bf16 v49, s33, v117
    v_dot2c_f32_bf16 v51, v117, v117
    v_dot2c_f32_bf16 v48, s33, v118
    v_dot2c_f32_bf16 v50, v118, v118
    v_dot2c_f32_bf16 v49, s33, v119
    v_dot2c_f32_bf16 v51, v119, v119
    s_waitcnt lgkmcnt(1)
    v_dot2c_f32_bf16 v48, s33, v120
    v_dot2c_f32_bf16 v50, v120, v120
    v_dot2c_f32_bf16 v49, s33, v121
    v_dot2c_f32_bf16 v51, v121, v121
    v_dot2c_f32_bf16 v48, s33, v122
    v_dot2c_f32_bf16 v50, v122, v122
    v_dot2c_f32_bf16 v49, s33, v123
    v_dot2c_f32_bf16 v51, v123, v123
    s_waitcnt lgkmcnt(0)
    v_dot2c_f32_bf16 v48, s33, v124
    v_dot2c_f32_bf16 v50, v124, v124
    v_dot2c_f32_bf16 v49, s33, v125
    v_dot2c_f32_bf16 v51, v125, v125
    v_dot2c_f32_bf16 v48, s33, v126
    v_dot2c_f32_bf16 v50, v126, v126
    v_dot2c_f32_bf16 v49, s33, v127
    v_dot2c_f32_bf16 v51, v127, v127
    s_nop 2
    v_add_f32 v48, v48, v49
    v_add_f32 v50, v50, v51
    v_mov_b32 v52, v48
    v_mov_b32 v53, v50
    s_nop 1
    v_permlane32_swap_b32 v48, v52
    v_permlane32_swap_b32 v50, v53
    s_nop 1
    v_add_f32 v48, v48, v52
    v_add_f32 v50, v50, v53
    v_mul_f32 v48, 0x3b124925, v48
    v_mul_f32 v50, 0x3b124925, v50
    v_fma_f32 v50, -v48, v48, v50
    v_max_f32 v50, 0, v50
    v_cvt_pk_bf16_f32 v50, v50, v50
    v_lshlrev_b32 v50, 16, v50
    v_add_f32 v50, 0x3727c5ac, v50
    v_cvt_pk_bf16_f32 v50, v50, v50
    v_lshlrev_b32 v50, 16, v50
    v_sqrt_f32 v50, v50
    s_waitcnt vmcnt(0)
L_toks:
    v_readfirstlane_b32 s32, v32
    s_cmp_lg_u32 s32, 0
    s_cbranch_scc1 L_tok_oks
    s_cmp_eq_u32 s40, 0
    s_cbranch_scc1 L_tok_oks
    s_sub_u32 s40, s40, 1
    s_sleep 2
    buffer_load_dword v32, v31, s[76:79], 0 offen sc1
    s_waitcnt vmcnt(0)
    s_branch L_toks
L_tok_oks:
    v_cvt_pk_bf16_f32 v64, -v48, -v48
    v_cvt_pk_bf16_f32 v65, -v48, v50
    v_mov_b32 v66, 0
    v_mov_b32 v67, v32
    v_lshlrev_b32 v176, 4, v176
    s_lshl_b32 s24, s6, 2
    s_add_u32 s24, s24, s3
    s_lshl_b32 s24, s24, 9
    s_add_u32 s24, s24, 16384
    buffer_store_dwordx4 v[64:67], v176, s[56:59], s24 offen sc1
    s_endpgm
L_hcs:
    v_lshlrev_b32 v176, 6, v29
    v_lshl_add_u32 v176, v29, 8, v176
    v_lshrrev_b32 v177, 1, v28
    v_lshl_add_u32 v176, v177, 11, v176
    v_and_b32 v177, 1, v28
    v_lshl_add_u32 v176, v177, 5, v176
    v_lshl_add_u32 v176, v30, 3, v176
    v_add_u32 v16, s30, v176
    v_xor_b32 v17, 64, v16
    v_xor_b32 v18, 128, v16
    v_xor_b32 v19, 192, v16
    v_and_b32 v178, 127, v0
    s_lshl_b32 s24, s7, 8
    v_lshl_add_u32 v179, v178, 1, s24
    global_load_ushort v33, v179, s[20:21]
    s_waitcnt vmcnt(26)
    ds_read_b64_tr_b16 v[112:113], v16 offset:0
    ds_read_b64_tr_b16 v[114:115], v16 offset:1024
    ds_read_b64_tr_b16 v[116:117], v17 offset:0
    ds_read_b64_tr_b16 v[118:119], v17 offset:1024
    ds_read_b64_tr_b16 v[120:121], v18 offset:0
    ds_read_b64_tr_b16 v[122:123], v18 offset:1024
    ds_read_b64_tr_b16 v[124:125], v19 offset:0
    ds_read_b64_tr_b16 v[126:127], v19 offset:1024
    s_waitcnt lgkmcnt(6)
    v_dot2c_f32_bf16 v48, s33, v112
    v_dot2c_f32_bf16 v48, s33, v113
    v_dot2c_f32_bf16 v48, s33, v114
    v_dot2c_f32_bf16 v48, s33, v115
    s_waitcnt lgkmcnt(4)
    v_dot2c_f32_bf16 v49, s33, v116
    v_dot2c_f32_bf16 v49, s33, v117
    v_dot2c_f32_bf16 v49, s33, v118
    v_dot2c_f32_bf16 v49, s33, v119
    s_waitcnt lgkmcnt(2)
    v_dot2c_f32_bf16 v50, s33, v120
    v_dot2c_f32_bf16 v50, s33, v121
    v_dot2c_f32_bf16 v50, s33, v122
    v_dot2c_f32_bf16 v50, s33, v123
    s_waitcnt lgkmcnt(0)
    v_dot2c_f32_bf16 v51, s33, v124
    v_dot2c_f32_bf16 v51, s33, v125
    v_dot2c_f32_bf16 v51, s33, v126
    v_dot2c_f32_bf16 v51, s33, v127
    s_waitcnt vmcnt(22)
    ds_read_b64_tr_b16 v[112:113], v16 offset:16384
    ds_read_b64_tr_b16 v[114:115], v16 offset:17408
    ds_read_b64_tr_b16 v[116:117], v17 offset:16384
    ds_read_b64_tr_b16 v[118:119], v17 offset:17408
    ds_read_b64_tr_b16 v[120:121], v18 offset:16384
    ds_read_b64_tr_b16 v[122:123], v18 offset:17408
    ds_read_b64_tr_b16 v[124:125], v19 offset:16384
    ds_read_b64_tr_b16 v[126:127], v19 offset:17408
    s_waitcnt lgkmcnt(6)
    v_dot2c_f32_bf16 v48, s33, v112
    v_dot2c_f32_bf16 v48, s33, v113
    v_dot2c_f32_bf16 v48, s33, v114
    v_dot2c_f32_bf16 v48, s33, v115
    s_waitcnt lgkmcnt(4)
    v_dot2c_f32_bf16 v49, s33, v116
    v_dot2c_f32_bf16 v49, s33, v117
    v_dot2c_f32_bf16 v49, s33, v118
    v_dot2c_f32_bf16 v49, s33, v119
    s_waitcnt lgkmcnt(2)
    v_dot2c_f32_bf16 v50, s33, v120
    v_dot2c_f32_bf16 v50, s33, v121
    v_dot2c_f32_bf16 v50, s33, v122
    v_dot2c_f32_bf16 v50, s33, v123
    s_waitcnt lgkmcnt(0)
    v_dot2c_f32_bf16 v51, s33, v124
    v_dot2c_f32_bf16 v51, s33, v125
    v_dot2c_f32_bf16 v51, s33, v126
    v_dot2c_f32_bf16 v51, s33, v127
    s_waitcnt vmcnt(18)
    ds_read_b64_tr_b16 v[112:113], v16 offset:32768
    ds_read_b64_tr_b16 v[114:115], v16 offset:33792
    ds_read_b64_tr_b16 v[116:117], v17 offset:32768
    ds_read_b64_tr_b16 v[118:119], v17 offset:33792
    ds_read_b64_tr_b16 v[120:121], v18 offset:32768
    ds_read_b64_tr_b16 v[122:123], v18 offset:33792
    ds_read_b64_tr_b16 v[124:125], v19 offset:32768
    ds_read_b64_tr_b16 v[126:127], v19 offset:33792
    s_waitcnt lgkmcnt(6)
    v_dot2c_f32_bf16 v48, s33, v112
    v_dot2c_f32_bf16 v48, s33, v113
    v_dot2c_f32_bf16 v48, s33, v114
    v_dot2c_f32_bf16 v48, s33, v115
    s_waitcnt lgkmcnt(4)
    v_dot2c_f32_bf16 v49, s33, v116
    v_dot2c_f32_bf16 v49, s33, v117
    v_dot2c_f32_bf16 v49, s33, v118
    v_dot2c_f32_bf16 v49, s33, v119
    s_waitcnt lgkmcnt(2)
    v_dot2c_f32_bf16 v50, s33, v120
    v_dot2c_f32_bf16 v50, s33, v121
    v_dot2c_f32_bf16 v50, s33, v122
    v_dot2c_f32_bf16 v50, s33, v123
    s_waitcnt lgkmcnt(0)
    v_dot2c_f32_bf16 v51, s33, v124
    v_dot2c_f32_bf16 v51, s33, v125
    v_dot2c_f32_bf16 v51, s33, v126
    v_dot2c_f32_bf16 v51, s33, v127
    s_waitcnt vmcnt(14)
    ds_read_b64_tr_b16 v[112:113], v16 offset:49152
    ds_read_b64_tr_b16 v[114:115], v16 offset:50176
    ds_read_b64_tr_b16 v[116:117], v17 offset:49152
    ds_read_b64_tr_b16 v[118:119], v17 offset:50176
    ds_read_b64_tr_b16 v[120:121], v18 offset:49152
    ds_read_b64_tr_b16 v[122:123], v18 offset:50176
    ds_read_b64_tr_b16 v[124:125], v19 offset:49152
    ds_read_b64_tr_b16 v[126:127], v19 offset:50176
    s_waitcnt lgkmcnt(6)
    v_dot2c_f32_bf16 v48, s33, v112
    v_dot2c_f32_bf16 v48, s33, v113
    v_dot2c_f32_bf16 v48, s33, v114
    v_dot2c_f32_bf16 v48, s33, v115
    s_waitcnt lgkmcnt(4)
    v_dot2c_f32_bf16 v49, s33, v116
    v_dot2c_f32_bf16 v49, s33, v117
    v_dot2c_f32_bf16 v49, s33, v118
    v_dot2c_f32_bf16 v49, s33, v119
    s_waitcnt lgkmcnt(2)
    v_dot2c_f32_bf16 v50, s33, v120
    v_dot2c_f32_bf16 v50, s33, v121
    v_dot2c_f32_bf16 v50, s33, v122
    v_dot2c_f32_bf16 v50, s33, v123
    s_waitcnt lgkmcnt(0)
    v_dot2c_f32_bf16 v51, s33, v124
    v_dot2c_f32_bf16 v51, s33, v125
    v_dot2c_f32_bf16 v51, s33, v126
    v_dot2c_f32_bf16 v51, s33, v127
    s_waitcnt vmcnt(10)
    v_add_u32 v16, 65536, v16
    v_add_u32 v17, 65536, v17
    v_add_u32 v18, 65536, v18
    v_add_u32 v19, 65536, v19
    ds_read_b64_tr_b16 v[112:113], v16 offset:0
    ds_read_b64_tr_b16 v[114:115], v16 offset:1024
    ds_read_b64_tr_b16 v[116:117], v17 offset:0
    ds_read_b64_tr_b16 v[118:119], v17 offset:1024
    ds_read_b64_tr_b16 v[120:121], v18 offset:0
    ds_read_b64_tr_b16 v[122:123], v18 offset:1024
    ds_read_b64_tr_b16 v[124:125], v19 offset:0
    ds_read_b64_tr_b16 v[126:127], v19 offset:1024
    s_waitcnt lgkmcnt(6)
    v_dot2c_f32_bf16 v48, s33, v112
    v_dot2c_f32_bf16 v48, s33, v113
    v_dot2c_f32_bf16 v48, s33, v114
    v_dot2c_f32_bf16 v48, s33, v115
    s_waitcnt lgkmcnt(4)
    v_dot2c_f32_bf16 v49, s33, v116
    v_dot2c_f32_bf16 v49, s33, v117
    v_dot2c_f32_bf16 v49, s33, v118
    v_dot2c_f32_bf16 v49, s33, v119
    s_waitcnt lgkmcnt(2)
    v_dot2c_f32_bf16 v50, s33, v120
    v_dot2c_f32_bf16 v50, s33, v121
    v_dot2c_f32_bf16 v50, s33, v122
    v_dot2c_f32_bf16 v50, s33, v123
    s_waitcnt lgkmcnt(0)
    v_dot2c_f32_bf16 v51, s33, v124
    v_dot2c_f32_bf16 v51, s33, v125
    v_dot2c_f32_bf16 v51, s33, v126
    v_dot2c_f32_bf16 v51, s33, v127
    s_waitcnt vmcnt(6)
    ds_read_b64_tr_b16 v[112:113], v16 offset:16384
    ds_read_b64_tr_b16 v[114:115], v16 offset:17408
    ds_read_b64_tr_b16 v[116:117], v17 offset:16384
    ds_read_b64_tr_b16 v[118:119], v17 offset:17408
    ds_read_b64_tr_b16 v[120:121], v18 offset:16384
    ds_read_b64_tr_b16 v[122:123], v18 offset:17408
    ds_read_b64_tr_b16 v[124:125], v19 offset:16384
    ds_read_b64_tr_b16 v[126:127], v19 offset:17408
    s_waitcnt lgkmcnt(6)
    v_dot2c_f32_bf16 v48, s33, v112
    v_dot2c_f32_bf16 v48, s33, v113
    v_dot2c_f32_bf16 v48, s33, v114
    v_dot2c_f32_bf16 v48, s33, v115
    s_waitcnt lgkmcnt(4)
    v_dot2c_f32_bf16 v49, s33, v116
    v_dot2c_f32_bf16 v49, s33, v117
    v_dot2c_f32_bf16 v49, s33, v118
    v_dot2c_f32_bf16 v49, s33, v119
    s_waitcnt lgkmcnt(2)
    v_dot2c_f32_bf16 v50, s33, v120
    v_dot2c_f32_bf16 v50, s33, v121
    v_dot2c_f32_bf16 v50, s33, v122
    v_dot2c_f32_bf16 v50, s33, v123
    s_waitcnt lgkmcnt(0)
    v_dot2c_f32_bf16 v51, s33, v124
    v_dot2c_f32_bf16 v51, s33, v125
    v_dot2c_f32_bf16 v51, s33, v126
    v_dot2c_f32_bf16 v51, s33, v127
    s_waitcnt vmcnt(2)
    ds_read_b64_tr_b16 v[112:113], v16 offset:32768
    ds_read_b64_tr_b16 v[114:115], v16 offset:33792
    ds_read_b64_tr_b16 v[116:117], v17 offset:32768
    ds_read_b64_tr_b16 v[118:119], v17 offset:33792
    ds_read_b64_tr_b16 v[120:121], v18 offset:32768
    ds_read_b64_tr_b16 v[122:123], v18 offset:33792
    ds_read_b64_tr_b16 v[124:125], v19 offset:32768
    ds_read_b64_tr_b16 v[126:127], v19 offset:33792
    s_waitcnt lgkmcnt(6)
    v_dot2c_f32_bf16 v48, s33, v112
    v_dot2c_f32_bf16 v48, s33, v113
    v_dot2c_f32_bf16 v48, s33, v114
    v_dot2c_f32_bf16 v48, s33, v115
    s_waitcnt lgkmcnt(4)
    v_dot2c_f32_bf16 v49, s33, v116
    v_dot2c_f32_bf16 v49, s33, v117
    v_dot2c_f32_bf16 v49, s33, v118
    v_dot2c_f32_bf16 v49, s33, v119
    s_waitcnt lgkmcnt(2)
    v_dot2c_f32_bf16 v50, s33, v120
    v_dot2c_f32_bf16 v50, s33, v121
    v_dot2c_f32_bf16 v50, s33, v122
    v_dot2c_f32_bf16 v50, s33, v123
    s_waitcnt lgkmcnt(0)
    v_dot2c_f32_bf16 v51, s33, v124
    v_dot2c_f32_bf16 v51, s33, v125
    v_dot2c_f32_bf16 v51, s33, v126
    v_dot2c_f32_bf16 v51, s33, v127
    v_lshlrev_b32 v176, 2, v1
    s_lshl_b32 s24, s3, 10
    s_add_u32 s24, s24, 131072
    v_add_u32 v176, s24, v176
    ds_write_b32 v176, v48 offset:0
    ds_write_b32 v176, v49 offset:256
    ds_write_b32 v176, v50 offset:512
    ds_write_b32 v176, v51 offset:768
    v_lshrrev_b32 v177, 5, v178
    v_and_b32 v179, 31, v178
    v_lshlrev_b32 v179, 2, v179
    v_lshl_add_u32 v177, v177, 8, v179
    v_add_u32 v177, 131072, v177
    s_waitcnt lgkmcnt(0)
    s_barrier
    ds_read2_b32 v[112:113], v177 offset0:0 offset1:32
    v_add_u32 v177, 1024, v177
    ds_read2_b32 v[114:115], v177 offset0:0 offset1:32
    v_add_u32 v177, 1024, v177
    ds_read2_b32 v[116:117], v177 offset0:0 offset1:32
    v_add_u32 v177, 1024, v177
    ds_read2_b32 v[118:119], v177 offset0:0 offset1:32
    s_waitcnt vmcnt(0) lgkmcnt(0)
L_tokc:
    v_readfirstlane_b32 s32, v32
    s_cmp_lg_u32 s32, 0
    s_cbranch_scc1 L_tok_okc
    s_cmp_eq_u32 s40, 0
    s_cbranch_scc1 L_tok_okc
    s_sub_u32 s40, s40, 1
    s_sleep 2
    buffer_load_dword v32, v31, s[76:79], 0 offen sc1
    s_waitcnt vmcnt(0)
    s_branch L_tokc
L_tok_okc:
    v_add_f32 v112, v112, v113
    v_add_f32 v112, v112, v114
    v_add_f32 v112, v112, v115
    v_add_f32 v112, v112, v116
    v_add_f32 v112, v112, v117
    v_add_f32 v112, v112, v118
    v_add_f32 v112, v112, v119
    v_cvt_pk_bf16_f32 v64, v112, v112
    v_lshlrev_b32 v176, 16, v64
    v_sub_f32 v176, v112, v176
    v_cvt_pk_bf16_f32 v64, v112, v176
    v_and_b32 v177, s4, v64
    v_sub_f32 v176, v176, v177
    v_lshlrev_b32 v177, 16, v33
    v_cvt_pk_bf16_f32 v65, v176, v177
    v_mov_b32 v66, 0
    v_mov_b32 v67, v32
    v_lshlrev_b32 v176, 4, v178
    s_lshl_b32 s24, s7, 11
    s_add_u32 s24, s24, 49152
    buffer_store_dwordx4 v[64:67], v176, s[56:59], s24 offen sc1
    s_endpgm
.fill 4096, 4, 0xbf800000
.section .rodata,"a"
.p2align 6
.amdhsa_kernel recurrent_scan__ssm_conv_h3__dense_activation_squared_relu__prompt_kernel
  .amdhsa_next_free_vgpr 512
  .amdhsa_next_free_sgpr 102
  .amdhsa_accum_offset 256
  .amdhsa_group_segment_fixed_size 0
  .amdhsa_kernarg_size 112
  .amdhsa_user_sgpr_count 2
  .amdhsa_user_sgpr_kernarg_segment_ptr 1
  .amdhsa_system_sgpr_workgroup_id_x 1
.end_amdhsa_kernel
```
